```python
import torch

def _softmax(x, axis=-1):
    return torch.softmax(x, dim=axis)
def _gelu(x):
    return torch.nn.functional.gelu(x, approximate="tanh")
def _silu(x):
    return torch.nn.functional.silu(x)
def _sigmoid(x):
    return torch.sigmoid(x)
def _layernorm(x, axis=-1, eps=1e-5):
    m = x.mean(dim=axis, keepdim=True)
    v = x.var(dim=axis, keepdim=True, unbiased=False)
    return (x - m) / torch.sqrt(v + eps)
def _scatter_add(tgt, idx, src, axis=0):
    return tgt.clone().index_add_(axis, idx, src)
def _segment_sum(src, seg, n):
    out = torch.zeros((n,) + src.shape[1:], dtype=src.dtype)
    return out.index_add_(0, seg, src)
def _pad(x, pw):
    flat = tuple(v for pair in reversed(pw) for v in pair)
    return torch.nn.functional.pad(x, flat)

kernel_name = 'gated_mix__gqa_block_cached__gqa_block_cached__decode'

def setup_inputs():

    _w = (lambda a: (lambda t: t.to(torch.bfloat16) if t.is_floating_point() else t)(torch.as_tensor(a)))
    def _A_setup():
        B, Sq, D = 2, 1, 576
        Hq, Hkv, Sk, Dh = 32, 16, 16384, 128
        assert Hq % Hkv == 0, (Hq, Hkv)
        return {
            "x": _w((lambda *s: torch.randn(*s, dtype=torch.bfloat16) * 0.05)(B, Sq, D)),
            "k_cache": _w((lambda *s: torch.randn(*s, dtype=torch.bfloat16) * 6.4)(B, Hkv, Sk, Dh)),
            "v_cache": _w((lambda *s: torch.randn(*s, dtype=torch.bfloat16) * 0.05)(B, Hkv, Sk, Dh)),
            "wq": _w((lambda *s: torch.randn(*s, dtype=torch.bfloat16) * 6.4)(D, Hq * Dh) * (D ** -0.5)),
            "wo": _w((lambda *s: torch.randn(*s, dtype=torch.bfloat16) * 0.05)(Hq * Dh, D) * ((Hq * Dh) ** -0.5)),
        }
    _A_in = _A_setup()

    def _B_setup():
        B, Sq, D = 2, 1, 576
        Hq, Hkv, Sk, Dh = 32, 16, 16384, 128
        assert Hq % Hkv == 0, (Hq, Hkv)
        return {
            "x": _w((lambda *s: torch.randn(*s, dtype=torch.bfloat16) * 0.05)(B, Sq, D)),
            "k_cache": _w((lambda *s: torch.randn(*s, dtype=torch.bfloat16) * 6.4)(B, Hkv, Sk, Dh)),
            "v_cache": _w((lambda *s: torch.randn(*s, dtype=torch.bfloat16) * 0.05)(B, Hkv, Sk, Dh)),
            "wq": _w((lambda *s: torch.randn(*s, dtype=torch.bfloat16) * 6.4)(D, Hq * Dh) * (D ** -0.5)),
            "wo": _w((lambda *s: torch.randn(*s, dtype=torch.bfloat16) * 0.05)(Hq * Dh, D) * ((Hq * Dh) ** -0.5)),
        }
    _B_in = _B_setup()

    return {
        "A_x": _A_in["x"],
        "A_k_cache": _A_in["k_cache"],
        "A_v_cache": _A_in["v_cache"],
        "A_wq": _A_in["wq"],
        "A_wo": _A_in["wo"],
        "B_x": _B_in["x"],
        "B_k_cache": _B_in["k_cache"],
        "B_v_cache": _B_in["v_cache"],
        "B_wq": _B_in["wq"],
        "B_wo": _B_in["wo"],
        "gate_w": _w((lambda *s: torch.randn(*s, dtype=torch.bfloat16) * 0.05)(576) * 16.0),
    }

def reference(A_x, A_k_cache, A_v_cache, A_wq, A_wo, B_x, B_k_cache, B_v_cache, B_wq, B_wo, gate_w):
    def _A_ref(x, k_cache, v_cache, wq, wo):
        B, Sq, D = x.shape
        Hq, Dh = 32, 128
        Hkv = k_cache.shape[1]
        rep = Hq // Hkv
        q = (lambda x, *d: x.permute(*d))((x @ wq).reshape(B, Sq, Hq, Dh), 0, 2, 1, 3)
        k = (lambda x, n, axis: torch.repeat_interleave(x, n, dim=axis))(k_cache, rep, axis=1)
        v = (lambda x, n, axis: torch.repeat_interleave(x, n, dim=axis))(v_cache, rep, axis=1)
        scores = torch.einsum("bhqd,bhkd->bhqk", q, k) * (Dh ** -0.5)
        p = _softmax(scores, axis=-1)
        o = torch.einsum("bhqk,bhkd->bhqd", p, v)
        return (lambda x, *d: x.permute(*d))(o, 0, 2, 1, 3).reshape(B, Sq, Hq * Dh) @ wo

    def _B_ref(x, k_cache, v_cache, wq, wo):
        B, Sq, D = x.shape
        Hq, Dh = 32, 128
        Hkv = k_cache.shape[1]
        rep = Hq // Hkv
        q = (lambda x, *d: x.permute(*d))((x @ wq).reshape(B, Sq, Hq, Dh), 0, 2, 1, 3)
        k = (lambda x, n, axis: torch.repeat_interleave(x, n, dim=axis))(k_cache, rep, axis=1)
        v = (lambda x, n, axis: torch.repeat_interleave(x, n, dim=axis))(v_cache, rep, axis=1)
        scores = torch.einsum("bhqd,bhkd->bhqk", q, k) * (Dh ** -0.5)
        p = _softmax(scores, axis=-1)
        o = torch.einsum("bhqk,bhkd->bhqd", p, v)
        return (lambda x, *d: x.permute(*d))(o, 0, 2, 1, 3).reshape(B, Sq, Hq * Dh) @ wo

    x = A_x
    g = _sigmoid((x * gate_w).sum(-1, keepdims=True))
    a = _A_ref(x, A_k_cache, A_v_cache, A_wq, A_wo)
    b = _B_ref(x, B_k_cache, B_v_cache, B_wq, B_wo)
    return g * a + (1 - g) * b
```

```asm
; @launch grid=(256,1,1) block=(448,1,1) lds=163840
.amdgcn_target "amdgcn-amd-amdhsa--gfx950"
.text
.globl gated_mix__gqa_block_cached__gqa_block_cached__decode_kernel
.p2align 8
.type gated_mix__gqa_block_cached__gqa_block_cached__decode_kernel,@function
gated_mix__gqa_block_cached__gqa_block_cached__decode_kernel:
    s_cmpk_ge_u32 s2, 0x100
    s_cbranch_scc1 L_exit
    s_load_dwordx2 s[8:9], s[0:1], 8
    v_lshrrev_b32 v1, 6, v0
    v_and_b32 v0, 63, v0
    v_readfirstlane_b32 s61, v1
    v_lshrrev_b32 v2, 4, v0
    v_and_b32 v3, 15, v0
    s_and_b32 s56, s2, 1
    s_lshl_b32 s56, s56, 4
    s_and_b32 s3, s2, 2
    s_lshl_b32 s3, s3, 2
    s_or_b32 s56, s56, s3
    s_and_b32 s3, s2, 4
    s_lshl_b32 s3, s3, 4
    s_or_b32 s56, s56, s3
    s_and_b32 s3, s2, 56
    s_lshr_b32 s3, s3, 3
    s_or_b32 s56, s56, s3
    s_and_b32 s3, s2, 64
    s_lshr_b32 s3, s3, 1
    s_or_b32 s56, s56, s3
    s_and_b32 s3, s2, 128
    s_or_b32 s56, s56, s3
    s_cmp_lg_u32 s61, 0
    s_cbranch_scc1 L_others
    s_brev_b32 s10, 16
    v_xor_b32 v24, v2, v3
    v_lshlrev_b32 v24, 4, v24
    v_and_b32 v30, 1, v2
    v_lshl_add_u32 v24, v30, 11, v24
    v_lshrrev_b32 v30, 1, v2
    v_lshl_add_u32 v30, v30, 13, v24
    v_xor_b32 v31, 16448, v30
    v_xor_b32 v32, 2097280, v30
    v_xor_b32 v33, 2113728, v30
    s_mov_b32 s11, 0x20000
    s_lshr_b32 s64, s56, 3
    s_lshl_b32 s64, s64, 22
    s_and_b32 s3, s56, 1
    s_lshl_b32 s3, s3, 20
    s_or_b32 s64, s64, s3
    s_and_b32 s3, s56, 2
    s_lshl_b32 s3, s3, 14
    s_or_b32 s64, s64, s3
    s_and_b32 s3, s56, 4
    s_lshl_b32 s3, s3, 14
    s_or_b32 s64, s64, s3
    s_mov_b32 s68, s64
    s_movk_i32 m0, 16384
    s_waitcnt lgkmcnt(0)
L_first:
    buffer_load_dwordx4 v30, s[8:11], s68 offen nt lds
    s_addk_i32 m0, 0x400
    s_nop 0
    buffer_load_dwordx4 v31, s[8:11], s68 offen nt lds
    s_addk_i32 m0, 0x400
    s_nop 0
    buffer_load_dwordx4 v32, s[8:11], s68 offen nt lds
    s_addk_i32 m0, 0x400
    s_nop 0
    buffer_load_dwordx4 v33, s[8:11], s68 offen nt lds
    s_addk_i32 m0, 0x400
    s_bitcmp1_b32 m0, 12
    s_cselect_b32 s3, 0, 4096
    s_xor_b32 s3, s3, 256
    s_xor_b32 s68, s68, s3
    s_bitcmp0_b32 m0, 15
    s_cbranch_scc1 L_first
    s_load_dwordx2 s[42:43], s[0:1], 16
    s_load_dwordx4 s[36:39], s[0:1], 48
    s_load_dwordx2 s[44:45], s[0:1], 32
    s_load_dwordx2 s[46:47], s[0:1], 72
    v_mov_b32 v1, 0
    s_bfe_u32 s58, s56, 0x10007
    s_and_b32 s57, s56, 7
    s_bfe_u32 s60, s56, 0x40003
    s_mov_b32 s63, 0x400000
    v_lshlrev_b32 v17, 2, v0
    v_mov_b32 v34, 2
    ds_write_b32 v17, v1
    ds_write_b32 v1, v34 offset:52
    v_lshlrev_b32 v24, 4, v3
    v_and_b32 v17, 1, v2
    v_lshl_add_u32 v24, v17, 11, v24
    v_lshrrev_b32 v17, 1, v2
    v_lshl_add_u32 v17, v17, 13, v24
    v_mov_b32 v20, 0
    v_mov_b32 v21, 0
    v_mov_b32 v22, 0
    v_mov_b32 v23, 0
    s_mov_b32 s72, s64
    s_mov_b32 s65, 16384
    s_mov_b32 s66, -7
    s_mov_b32 s67, 0
    s_mov_b32 s77, 0
    s_mov_b32 s73, 0
    s_mov_b32 s75, 0
    s_mov_b32 s12, 256
    s_mov_b32 s13, 4096
    s_mov_b32 s14, 4352
    s_movk_i32 s69, 128
    s_waitcnt lgkmcnt(0)
    s_barrier
L_ld_next:
    s_addk_i32 s65, 0x4000
    s_cmp_eq_u32 s65, 163840
    s_cselect_b32 s65, 16384, s65
    s_add_u32 s67, s67, 4
    s_add_u32 s77, s77, 1
    s_mov_b32 s64, s72
    s_and_b32 s3, s77, 1
    s_lshl_b32 s3, s3, 10
    s_or_b32 s64, s64, s3
    s_and_b32 s3, s77, 2
    s_lshl_b32 s3, s3, 8
    s_or_b32 s64, s64, s3
    s_and_b32 s3, s77, 4
    s_lshl_b32 s3, s3, 15
    s_or_b32 s64, s64, s3
    s_and_b32 s3, s77, 8
    s_lshl_b32 s3, s3, 16
    s_or_b32 s64, s64, s3
    s_and_b32 s3, s77, 16
    s_lshl_b32 s3, s3, 14
    s_or_b32 s64, s64, s3
    s_cmp_eq_u32 s67, s69
    s_cbranch_scc1 L_ld_phase
L_ld_go:
L_chk_1:
    s_waitcnt lgkmcnt(0)
    v_min3_i32 v24, v20, v21, v22
    v_min_i32 v24, v24, v23
    v_readfirstlane_b32 s3, v34
    v_readfirstlane_b32 s70, v24
    s_cmp_ge_i32 s70, s66
    s_cbranch_scc1 L_ok_2
    ds_read_b128 v[20:23], v1 offset:16
    s_sub_u32 s63, s63, 1
    s_cbranch_scc1 L_end
    s_branch L_chk_1
L_ok_2:
    s_add_u32 s66, s66, 1
    s_cmp_ge_i32 s3, 4
    s_cbranch_scc1 L_t0_7
    s_cmp_ge_i32 s3, 2
    s_cbranch_scc1 L_t0_3
    s_cmp_ge_i32 s3, 1
    s_cbranch_scc1 L_b1
    s_branch L_b0
L_t0_3:
    s_cmp_ge_i32 s3, 3
    s_cbranch_scc1 L_b3
    s_branch L_b2
L_t0_7:
    s_cmp_ge_i32 s3, 6
    s_cbranch_scc1 L_t4_7
    s_cmp_ge_i32 s3, 5
    s_cbranch_scc1 L_b5
    s_branch L_b4
L_t4_7:
    s_cmp_ge_i32 s3, 7
    s_cbranch_scc1 L_b7
    s_branch L_b6
L_b2:
    s_mov_b32 m0, s65
    s_waitcnt vmcnt(21)
    buffer_load_dwordx4 v30, s[8:11], s64 offen nt lds
    s_addk_i32 m0, 0x400
    s_add_i32 s70, s67, -5
    s_max_i32 s73, s73, s70
    v_mov_b32 v19, s73
    s_waitcnt vmcnt(21)
    ds_write_b32 v1, v19 offset:0
    buffer_load_dwordx4 v31, s[8:11], s64 offen nt lds
    s_addk_i32 m0, 0x400
    s_waitcnt vmcnt(21)
    buffer_load_dwordx4 v32, s[8:11], s64 offen nt lds
    s_addk_i32 m0, 0x400
    s_waitcnt vmcnt(21)
    buffer_load_dwordx4 v33, s[8:11], s64 offen nt lds
    s_addk_i32 m0, 0x400
    s_add_u32 s68, s64, s12
    s_waitcnt vmcnt(21)
    buffer_load_dwordx4 v30, s[8:11], s68 offen nt lds
    s_addk_i32 m0, 0x400
    s_add_i32 s70, s67, -4
    s_max_i32 s73, s73, s70
    v_mov_b32 v19, s73
    s_waitcnt vmcnt(21)
    ds_write_b32 v1, v19 offset:0
    buffer_load_dwordx4 v31, s[8:11], s68 offen nt lds
    s_addk_i32 m0, 0x400
    s_waitcnt vmcnt(21)
    buffer_load_dwordx4 v32, s[8:11], s68 offen nt lds
    s_addk_i32 m0, 0x400
    s_waitcnt vmcnt(21)
    buffer_load_dwordx4 v33, s[8:11], s68 offen nt lds
    s_addk_i32 m0, 0x400
    s_add_u32 s68, s64, s13
    s_waitcnt vmcnt(21)
    buffer_load_dwordx4 v30, s[8:11], s68 offen nt lds
    s_addk_i32 m0, 0x400
    s_add_i32 s70, s67, -3
    s_max_i32 s73, s73, s70
    v_mov_b32 v19, s73
    s_waitcnt vmcnt(21)
    ds_write_b32 v1, v19 offset:0
    buffer_load_dwordx4 v31, s[8:11], s68 offen nt lds
    s_addk_i32 m0, 0x400
    s_waitcnt vmcnt(21)
    buffer_load_dwordx4 v32, s[8:11], s68 offen nt lds
    ds_read_b128 v[20:23], v1 offset:16
    ds_read_b32 v34, v1 offset:52
    s_addk_i32 m0, 0x400
    s_waitcnt vmcnt(21)
    buffer_load_dwordx4 v33, s[8:11], s68 offen nt lds
    s_addk_i32 m0, 0x400
    s_add_u32 s68, s64, s14
    s_waitcnt vmcnt(21)
    buffer_load_dwordx4 v30, s[8:11], s68 offen nt lds
    s_addk_i32 m0, 0x400
    s_add_i32 s70, s67, -2
    s_max_i32 s73, s73, s70
    v_mov_b32 v19, s73
    s_waitcnt vmcnt(21)
    ds_write_b32 v1, v19 offset:0
    buffer_load_dwordx4 v31, s[8:11], s68 offen nt lds
    s_addk_i32 m0, 0x400
    s_waitcnt vmcnt(21)
    buffer_load_dwordx4 v32, s[8:11], s68 offen nt lds
    s_addk_i32 m0, 0x400
    s_waitcnt vmcnt(21)
    buffer_load_dwordx4 v33, s[8:11], s68 offen nt lds
    s_branch L_ld_next
L_others:
    s_bfe_u32 s3, s56, 0x10007
    s_mul_i32 s3, s3, 40
    s_add_u32 s3, s3, 24
    s_load_dwordx2 s[44:45], s[0:1], s3
    s_load_dwordx2 s[24:25], s[0:1], 0
    s_load_dwordx8 s[48:55], s[0:1], 80
    v_mov_b32 v1, 0
    s_bfe_u32 s58, s56, 0x10007
    s_and_b32 s57, s56, 7
    s_bfe_u32 s60, s56, 0x40003
    s_mov_b32 s63, 0x400000
    s_mov_b32 s6, 555751040
    s_mov_b32 s7, 0x20000
    s_mov_b32 s71, 0x3fb8aa3b
    s_movk_i32 s26, 2304
    s_mov_b32 s27, 0x20000
    s_cmp_eq_u32 s61, 1
    s_cbranch_scc1 L_aux
    s_cmp_eq_u32 s61, 6
    s_cbranch_scc1 L_warm
    s_sub_u32 s62, s61, 2
    s_cmp_eq_u32 s62, 3
    s_cbranch_scc1 L_noproj
    s_mov_b32 s18, 4718592
    s_mov_b32 s19, 0x20000
    v_bfe_u32 v84, v0, 3, 1
    v_mul_u32_u24 v84, 1152, v84
    v_mul_u32_u24 v85, 72, v2
    v_add_u32 v90, v84, v85
    v_mul_u32_u24 v84, 294912, v2
    v_lshl_add_u32 v91, v3, 4, v84
    s_lshr_b32 s3, s57, 1
    s_mul_i32 s3, s3, 144
    s_mul_i32 s72, s62, 12
    s_add_u32 s3, s3, s72
    s_lshl_b32 s72, s3, 1
    s_lshl_b32 s3, s3, 13
    s_lshl_b32 s73, s60, 9
    s_add_u32 s3, s3, s73
    s_and_b32 s73, s57, 1
    s_lshl_b32 s73, s73, 8
    s_add_u32 s3, s3, s73
    s_waitcnt lgkmcnt(0)
    s_mov_b64 s[16:17], s[44:45]
    buffer_load_dwordx4 v[84:87], v90, s[24:27], s72 offen
    buffer_load_dwordx2 v[88:89], v90, s[24:27], s72 offen offset:16
    buffer_load_dwordx4 v[36:39], v91, s[16:19], s3 offen nt
    s_addk_i32 s3, 0x2000
    buffer_load_dwordx4 v[40:43], v91, s[16:19], s3 offen nt
    s_addk_i32 s3, 0x2000
    buffer_load_dwordx4 v[44:47], v91, s[16:19], s3 offen nt
    s_addk_i32 s3, 0x2000
    buffer_load_dwordx4 v[48:51], v91, s[16:19], s3 offen nt
    s_addk_i32 s3, 0x2000
    buffer_load_dwordx4 v[52:55], v91, s[16:19], s3 offen nt
    s_addk_i32 s3, 0x2000
    buffer_load_dwordx4 v[56:59], v91, s[16:19], s3 offen nt
    s_addk_i32 s3, 0x2000
    s_barrier
    buffer_load_dwordx4 v[60:63], v91, s[16:19], s3 offen nt
    s_addk_i32 s3, 0x2000
    buffer_load_dwordx4 v[64:67], v91, s[16:19], s3 offen nt
    s_addk_i32 s3, 0x2000
    buffer_load_dwordx4 v[68:71], v91, s[16:19], s3 offen nt
    s_addk_i32 s3, 0x2000
    buffer_load_dwordx4 v[72:75], v91, s[16:19], s3 offen nt
    s_addk_i32 s3, 0x2000
    buffer_load_dwordx4 v[76:79], v91, s[16:19], s3 offen nt
    s_addk_i32 s3, 0x2000
    buffer_load_dwordx4 v[80:83], v91, s[16:19], s3 offen nt
    v_and_b32 v96, 1, v0
    v_cmp_eq_u32 vcc, 1, v96
    v_mov_b32 v97, 0x0c0c0100
    v_mov_b32 v98, 0x01000c0c
    v_cndmask_b32 v97, v97, v98, vcc
    v_mov_b32 v98, 0x0c0c0302
    v_mov_b32 v99, 0x03020c0c
    v_cndmask_b32 v98, v98, v99, vcc
    v_bfe_u32 v96, v0, 1, 2
    v_mov_b32 v99, 0x0c0c0c0c
    v_cmp_eq_u32 vcc, 0, v96
    s_nop 1
    v_cndmask_b32 v4, v99, v97, vcc
    v_cndmask_b32 v8, v99, v98, vcc
    v_cmp_eq_u32 vcc, 1, v96
    s_nop 1
    v_cndmask_b32 v5, v99, v97, vcc
    v_cndmask_b32 v9, v99, v98, vcc
    v_cmp_eq_u32 vcc, 2, v96
    s_nop 1
    v_cndmask_b32 v6, v99, v97, vcc
    v_cndmask_b32 v10, v99, v98, vcc
    v_cmp_eq_u32 vcc, 3, v96
    s_nop 1
    v_cndmask_b32 v7, v99, v97, vcc
    v_cndmask_b32 v11, v99, v98, vcc
    s_waitcnt vmcnt(12)
    v_perm_b32 v96, v84, v84, v4
    v_perm_b32 v97, v84, v84, v5
    v_perm_b32 v98, v84, v84, v6
    v_perm_b32 v99, v84, v84, v7
    v_perm_b32 v100, v84, v84, v8
    v_perm_b32 v101, v84, v84, v9
    v_perm_b32 v102, v84, v84, v10
    v_perm_b32 v103, v84, v84, v11
    v_perm_b32 v104, v85, v85, v4
    v_perm_b32 v105, v85, v85, v5
    v_perm_b32 v106, v85, v85, v6
    v_perm_b32 v107, v85, v85, v7
    v_perm_b32 v108, v85, v85, v8
    v_perm_b32 v109, v85, v85, v9
    v_perm_b32 v110, v85, v85, v10
    v_perm_b32 v111, v85, v85, v11
    v_perm_b32 v112, v86, v86, v4
    v_perm_b32 v113, v86, v86, v5
    v_perm_b32 v114, v86, v86, v6
    v_perm_b32 v115, v86, v86, v7
    v_perm_b32 v116, v86, v86, v8
    v_perm_b32 v117, v86, v86, v9
    v_perm_b32 v118, v86, v86, v10
    v_perm_b32 v119, v86, v86, v11
    v_perm_b32 v120, v87, v87, v4
    v_perm_b32 v121, v87, v87, v5
    v_perm_b32 v122, v87, v87, v6
    v_perm_b32 v123, v87, v87, v7
    v_perm_b32 v124, v87, v87, v8
    v_perm_b32 v125, v87, v87, v9
    v_perm_b32 v126, v87, v87, v10
    v_perm_b32 v127, v87, v87, v11
    v_perm_b32 v128, v88, v88, v4
    v_perm_b32 v129, v88, v88, v5
    v_perm_b32 v130, v88, v88, v6
    v_perm_b32 v131, v88, v88, v7
    v_perm_b32 v132, v88, v88, v8
    v_perm_b32 v133, v88, v88, v9
    v_perm_b32 v134, v88, v88, v10
    v_perm_b32 v135, v88, v88, v11
    v_perm_b32 v136, v89, v89, v4
    v_perm_b32 v137, v89, v89, v5
    v_perm_b32 v138, v89, v89, v6
    v_perm_b32 v139, v89, v89, v7
    v_perm_b32 v140, v89, v89, v8
    v_perm_b32 v141, v89, v89, v9
    v_perm_b32 v142, v89, v89, v10
    v_perm_b32 v143, v89, v89, v11
    s_waitcnt vmcnt(11)
    v_mfma_f32_16x16x32_bf16 v[92:95], v[96:99], v[36:39], 0
    s_waitcnt vmcnt(10)
    v_mfma_f32_16x16x32_bf16 v[92:95], v[100:103], v[40:43], v[92:95]
    s_waitcnt vmcnt(9)
    v_mfma_f32_16x16x32_bf16 v[92:95], v[104:107], v[44:47], v[92:95]
    s_waitcnt vmcnt(8)
    v_mfma_f32_16x16x32_bf16 v[92:95], v[108:111], v[48:51], v[92:95]
    s_waitcnt vmcnt(7)
    v_mfma_f32_16x16x32_bf16 v[92:95], v[112:115], v[52:55], v[92:95]
    s_waitcnt vmcnt(6)
    v_mfma_f32_16x16x32_bf16 v[92:95], v[116:119], v[56:59], v[92:95]
    s_waitcnt vmcnt(5)
    v_mfma_f32_16x16x32_bf16 v[92:95], v[120:123], v[60:63], v[92:95]
    s_waitcnt vmcnt(4)
    v_mfma_f32_16x16x32_bf16 v[92:95], v[124:127], v[64:67], v[92:95]
    s_waitcnt vmcnt(3)
    v_mfma_f32_16x16x32_bf16 v[92:95], v[128:131], v[68:71], v[92:95]
    s_waitcnt vmcnt(2)
    v_mfma_f32_16x16x32_bf16 v[92:95], v[132:135], v[72:75], v[92:95]
    s_waitcnt vmcnt(1)
    v_mfma_f32_16x16x32_bf16 v[92:95], v[136:139], v[76:79], v[92:95]
    s_waitcnt vmcnt(0)
    v_mfma_f32_16x16x32_bf16 v[92:95], v[140:143], v[80:83], v[92:95]
    s_lshl_b32 s3, s62, 10
    v_lshl_add_u32 v96, v0, 4, s3
    v_mov_b32 v98, 1
    s_nop 4
    ds_write_b128 v96, v[92:95] offset:1024
    s_mov_b64 exec, 1
    ds_add_u32 v1, v98 offset:32
    s_mov_b64 exec, -1
    s_branch L_qwait
L_warm:
    s_barrier
    s_mov_b64 exec, 0
    s_branch L_pad0
L_aux:
L_pad0:
    s_cbranch_execz L_pad1
    s_movk_i32 s30, 256
    s_mov_b32 s31, 0x20000
    s_getreg_b32 s67, hwreg(HW_REG_XCC_ID, 0, 4)
    v_lshrrev_b32 v96, 3, v0
    v_lshlrev_b32 v96, 14, v96
    v_and_b32 v97, 7, v0
    v_lshl_add_u32 v13, v97, 7, v96
    v_lshlrev_b32 v96, 2, v3
    s_mov_b32 exec_lo, 0
L_pad1:
    s_cbranch_execz L_pad2
    v_add_u32 v13, 65536, v96
    s_mov_b64 exec, -1
    s_lshl_b32 s74, s60, 10
    s_add_u32 s79, s74, 458752
    s_add_u32 s74, s74, 393216
    s_lshl_b32 s77, s60, 2
    v_mov_b32 v24, -1
    v_mov_b32 v25, -1
    v_mov_b32 v26, -1
    v_mov_b32 v27, -1
    v_lshlrev_b32 v15, 4, v0
    s_lshl_b32 s73, s58, 3
    s_add_u32 s73, s73, s57
    s_lshl_b32 s59, s60, 4
    s_add_u32 s59, s59, s73
    s_mul_i32 s59, s59, 640
    s_add_u32 s75, s59, 163840
    s_lshl_b32 s69, s56, 10
    s_add_u32 s69, s69, 524288
    s_lshl_b32 s76, s56, 7
    s_add_u32 s76, s76, 393216
    s_mov_b32 s70, 0
    s_lshl_b32 s68, s73, 4
    s_add_u32 s68, s68, s60
    s_mul_i32 s16, s68, 2048
    s_add_u32 s16, s16, 2097152
    s_add_u32 s62, s16, 1024
    v_lshrrev_b32 v96, 3, v0
    v_mul_u32_u24 v96, 128, v96
    v_lshl_add_u32 v16, v97, 4, v96
    s_waitcnt lgkmcnt(0)
    s_mov_b64 s[4:5], s[54:55]
    s_mov_b64 s[28:29], s[52:53]
    s_and_b32 s3, s60, 3
    s_lshr_b32 s44, s60, 3
    s_lshl_b32 s44, s44, 2
    s_or_b32 s44, s44, s3
    s_lshl_b32 s45, s44, 8
    s_add_u32 s45, s45, 491520
    s_cmp_lg_u32 s73, 8
    s_cbranch_scc1 L_member
    v_mov_b32 v96, 0
    v_mov_b32 v97, 0
    s_mov_b32 exec_lo, 0xffff
    s_mov_b32 exec_hi, 0xffff
    buffer_load_dword v96, v13, s[4:7], s74 offen sc1
    s_mov_b64 exec, -1
L_pad2:
    s_cbranch_execz L_pad3
    s_bitcmp1_b32 s60, 2
    s_cbranch_scc1 L_noscan
    v_mul_u32_u24 v98, 16384, v0
    s_mul_i32 s3, s44, 2048
    s_add_u32 s3, s3, 1048576
    s_mov_b32 exec_hi, 0
    buffer_load_dword v97, v98, s[4:7], s3 offen sc1
    s_mov_b64 exec, 1
    buffer_store_dword v1, off, s[4:7], s45
    s_mov_b64 exec, -1
L_noscan:
    buffer_store_dwordx4 v[24:27], v15, s[4:7], s69 offen
    s_mov_b32 exec_hi, 0xff
    buffer_store_dwordx4 v[24:27], v15, s[4:7], s59 offen
    buffer_store_dwordx4 v[24:27], v15, s[4:7], s75 offen
    s_mov_b64 exec, -1
    s_barrier
    s_mov_b32 s64, 0
    s_waitcnt vmcnt(0)
L_pick:
    s_add_u32 s64, s64, 1
    v_cmp_eq_u32 vcc, s64, v96
    s_cbranch_vccnz L_pick
    v_cmp_eq_u32 vcc, s64, v97
    s_cbranch_vccnz L_pick
    s_lshl_b32 s66, s64, 4
    s_or_b32 s66, s66, s67
    v_mov_b32 v96, s66
    s_mov_b64 exec, 1
    buffer_store_dword v96, off, s[28:31], s77
    s_branch L_armed
L_member:
    s_cmp_ge_u32 s68, 72
    s_cbranch_scc1 L_nosnap
    buffer_load_dwordx4 v[68:71], v16, s[4:7], s16 offen sc1
    buffer_load_dwordx4 v[72:75], v16, s[4:7], s62 offen sc1
L_nosnap:
    buffer_store_dwordx4 v[24:27], v15, s[4:7], s69 offen
    s_mov_b32 exec_hi, 0xff
    buffer_store_dwordx4 v[24:27], v15, s[4:7], s59 offen
    buffer_store_dwordx4 v[24:27], v15, s[4:7], s75 offen
    s_mov_b64 exec, 1
    buffer_store_dword v1, off, s[28:31], s77 offset:64
    s_barrier
    s_waitcnt vmcnt(0)
L_armwait:
    buffer_load_dword v96, off, s[28:31], s77 sc1
    s_sub_u32 s63, s63, 1
    s_cbranch_scc1 L_end
L_pad3:
    s_cbranch_execz L_pad4
    s_add_u32 s70, s70, 1
    s_waitcnt vmcnt(0)
    v_readfirstlane_b32 s66, v96
    s_cmp_lg_u32 s66, 0
    s_cbranch_scc1 L_armseen
    s_and_b32 s3, s70, 3
    s_cbranch_scc1 L_armwait
    buffer_load_dword v96, off, s[28:31], s77 offset:128 sc1
    s_waitcnt vmcnt(0)
    v_readfirstlane_b32 s66, v96
    s_cmp_eq_u32 s66, 0
    s_cbranch_scc1 L_armwait
L_armseen:
    s_bfe_u32 s64, s66, 0x180004
L_armed:
    s_and_b32 s3, s66, 15
    s_cmp_lg_u32 s3, s67
    s_cselect_b32 s65, 1, 0
    v_mov_b32 v101, s64
    v_mov_b32 v98, s66
    s_cmp_eq_u32 s73, 8
    s_cselect_b32 s47, 0, 7
    s_cmp_eq_u32 s65, 1
    s_cbranch_scc1 L_noflag
    s_lshl_b32 s3, s73, 2
    s_add_u32 s3, s3, s79
    buffer_store_dword v101, off, s[4:7], s3
L_noflag:
    s_mov_b64 exec, -1
    v_lshrrev_b32 v96, 5, v0
    v_lshlrev_b32 v96, 9, v96
    v_lshl_add_u32 v96, v3, 5, v96
    v_and_b32 v97, 1, v2
    v_lshl_add_u32 v12, v97, 4, v96
L_lw_3:
    ds_read_b32 v96, v1 offset:32
    s_sub_u32 s63, s63, 1
    s_cbranch_scc1 L_end
    s_waitcnt lgkmcnt(0)
    v_readfirstlane_b32 s3, v96
    s_cmp_lt_u32 s3, 3
    s_cbranch_scc1 L_lw_3
    ds_read_b128 v[36:39], v15 offset:1024
    ds_read_b128 v[40:43], v15 offset:2048
    ds_read_b128 v[44:47], v15 offset:3072
    v_lshrrev_b32 v96, 5, v0
    v_lshlrev_b32 v96, 10, v96
    v_and_b32 v97, 31, v0
    v_lshl_add_u32 v14, v97, 4, v96
    s_lshl_b32 s40, s60, 13
    s_lshl_b32 s3, s58, 9
    s_add_u32 s40, s40, s3
    s_add_u32 s40, s40, 524288
    s_add_u32 s41, s40, 4096
    s_add_u32 s42, s40, 0x20000
L_pad4:
    s_cbranch_execz L_pad5
    s_add_u32 s43, s41, 0x20000
    s_waitcnt lgkmcnt(0)
    v_add_f32 v20, v36, v40
    v_add_f32 v21, v37, v41
    v_add_f32 v22, v38, v42
    v_add_f32 v23, v39, v43
    v_add_f32 v20, v20, v44
    v_add_f32 v21, v21, v45
    v_add_f32 v22, v22, v46
    v_add_f32 v23, v23, v47
    v_min_u32 v20, -2, v20
    v_min_u32 v21, -2, v21
    v_min_u32 v22, -2, v22
    v_min_u32 v23, -2, v23
    s_cmp_eq_u32 s65, 1
    s_cbranch_scc1 L_goslow
    buffer_store_dwordx4 v[20:23], v12, s[4:7], s69 offen
    s_mov_b32 s70, 0
L_fastwait:
    s_mov_b32 exec_hi, 0xffff
    s_mov_b32 exec_lo, 0
    buffer_load_dword v97, v13, s[4:7], s74 offen sc1
    s_sub_u32 s63, s63, 1
    s_cbranch_scc1 L_end
    s_add_u32 s70, s70, 1
    s_waitcnt vmcnt(0)
    v_cmp_ne_u32 vcc, s64, v97
    s_cbranch_vccnz L_fastmiss
L_flags_ok:
    s_cmp_lg_u32 s73, 8
    s_cbranch_scc1 L_notlead
    s_mov_b64 exec, 1
    v_or_b32 v98, 0x80000000, v98
    buffer_store_dword v98, off, s[28:31], s77 offset:128 sc1
    buffer_store_dword v1, off, s[28:31], s77
L_notlead:
    s_mov_b64 exec, -1
L_qgather:
    buffer_load_dwordx4 v[36:39], v14, s[4:7], s40 offen sc1
    buffer_load_dwordx4 v[40:43], v14, s[4:7], s40 offen offset:2048 sc1
    buffer_load_dwordx4 v[44:47], v14, s[4:7], s41 offen sc1
    buffer_load_dwordx4 v[48:51], v14, s[4:7], s41 offen offset:2048 sc1
    buffer_load_dwordx4 v[52:55], v14, s[4:7], s42 offen sc1
    buffer_load_dwordx4 v[56:59], v14, s[4:7], s42 offen offset:2048 sc1
    buffer_load_dwordx4 v[60:63], v14, s[4:7], s43 offen sc1
    buffer_load_dwordx4 v[64:67], v14, s[4:7], s43 offen offset:2048 sc1
    s_sub_u32 s63, s63, 1
    s_cbranch_scc1 L_end
    s_waitcnt vmcnt(0)
    v_max_u32 v100, v36, v37
    v_max3_u32 v100, v100, v38, v39
L_pad5:
    s_cbranch_execz L_pad6
    v_max3_u32 v100, v100, v40, v41
    v_max3_u32 v100, v100, v42, v43
    v_max3_u32 v100, v100, v44, v45
    v_max3_u32 v100, v100, v46, v47
    v_max3_u32 v100, v100, v48, v49
    v_max3_u32 v100, v100, v50, v51
    v_max3_u32 v100, v100, v52, v53
    v_max3_u32 v100, v100, v54, v55
    v_max3_u32 v100, v100, v56, v57
    v_max3_u32 v100, v100, v58, v59
    v_max3_u32 v100, v100, v60, v61
    v_max3_u32 v100, v100, v62, v63
    v_max3_u32 v100, v100, v64, v65
    v_max3_u32 v100, v100, v66, v67
    v_cmp_eq_u32 vcc, -1, v100
    s_cbranch_vccnz L_qgather
    v_lshlrev_b32 v99, 3, v0
    s_add_u32 s3, s65, 1
    v_mov_b32 v98, s3
    v_add_f32 v36, v36, v40
    v_add_f32 v37, v37, v41
    v_add_f32 v38, v38, v42
    v_add_f32 v39, v39, v43
    v_add_f32 v44, v44, v48
    v_add_f32 v45, v45, v49
    v_add_f32 v46, v46, v50
    v_add_f32 v47, v47, v51
    v_add_f32 v36, v36, v44
    v_add_f32 v37, v37, v45
    v_add_f32 v38, v38, v46
    v_add_f32 v39, v39, v47
    v_cvt_pk_bf16_f32 v36, v36, v37
    v_cvt_pk_bf16_f32 v37, v38, v39
    ds_write_b64 v99, v[36:37] offset:7168
    v_add_f32 v52, v52, v56
    v_add_f32 v53, v53, v57
    v_add_f32 v54, v54, v58
    v_add_f32 v55, v55, v59
    v_add_f32 v60, v60, v64
    v_add_f32 v61, v61, v65
    v_add_f32 v62, v62, v66
    v_add_f32 v63, v63, v67
    v_add_f32 v52, v52, v60
    v_add_f32 v53, v53, v61
    v_add_f32 v54, v54, v62
L_pad6:
    s_cbranch_execz L_pad7
    v_add_f32 v55, v55, v63
    v_cvt_pk_bf16_f32 v52, v52, v53
    v_cvt_pk_bf16_f32 v53, v54, v55
    ds_write_b64 v99, v[52:53] offset:7680
    ds_write_b32 v1, v98 offset:36
    s_mov_b64 s[36:37], s[48:49]
    s_movk_i32 s38, 1152
    s_mov_b32 s39, 0x20000
    v_mul_u32_u24 v96, 36, v0
    v_and_b32 v97, 31, v0
    v_mul_u32_u24 v97, 36, v97
    buffer_load_dwordx4 v[112:115], v96, s[24:27], 0 offen
    buffer_load_dwordx4 v[116:119], v96, s[24:27], 0 offen offset:16
    buffer_load_dword v120, v96, s[24:27], 0 offen offset:32
    buffer_load_dwordx4 v[122:125], v97, s[36:39], 0 offen
    buffer_load_dwordx4 v[126:129], v97, s[36:39], 0 offen offset:16
    buffer_load_dword v130, v97, s[36:39], 0 offen offset:32
    v_mov_b32 v132, 0
    v_lshrrev_b32 v96, 5, v0
    v_lshlrev_b32 v96, 3, v96
    s_waitcnt vmcnt(0)
    v_lshlrev_b32 v133, 16, v112
    v_and_b32 v134, 0xffff0000, v112
    v_lshlrev_b32 v135, 16, v122
    v_and_b32 v136, 0xffff0000, v122
    v_mul_f32 v133, v133, v135
    v_mul_f32 v134, v134, v136
    v_cvt_pk_bf16_f32 v133, v133, v134
    v_and_b32 v134, 0xffff0000, v133
    v_lshlrev_b32 v133, 16, v133
    v_add_f32 v132, v132, v133
    v_add_f32 v132, v132, v134
    v_lshlrev_b32 v133, 16, v113
    v_and_b32 v134, 0xffff0000, v113
    v_lshlrev_b32 v135, 16, v123
    v_and_b32 v136, 0xffff0000, v123
    v_mul_f32 v133, v133, v135
    v_mul_f32 v134, v134, v136
    v_cvt_pk_bf16_f32 v133, v133, v134
    v_and_b32 v134, 0xffff0000, v133
    v_lshlrev_b32 v133, 16, v133
    v_add_f32 v132, v132, v133
    v_add_f32 v132, v132, v134
    v_lshlrev_b32 v133, 16, v114
L_pad7:
    s_cbranch_execz L_pad8
    v_and_b32 v134, 0xffff0000, v114
    v_lshlrev_b32 v135, 16, v124
    v_and_b32 v136, 0xffff0000, v124
    v_mul_f32 v133, v133, v135
    v_mul_f32 v134, v134, v136
    v_cvt_pk_bf16_f32 v133, v133, v134
    v_and_b32 v134, 0xffff0000, v133
    v_lshlrev_b32 v133, 16, v133
    v_add_f32 v132, v132, v133
    v_add_f32 v132, v132, v134
    v_lshlrev_b32 v133, 16, v115
    v_and_b32 v134, 0xffff0000, v115
    v_lshlrev_b32 v135, 16, v125
    v_and_b32 v136, 0xffff0000, v125
    v_mul_f32 v133, v133, v135
    v_mul_f32 v134, v134, v136
    v_cvt_pk_bf16_f32 v133, v133, v134
    v_and_b32 v134, 0xffff0000, v133
    v_lshlrev_b32 v133, 16, v133
    v_add_f32 v132, v132, v133
    v_add_f32 v132, v132, v134
    v_lshlrev_b32 v133, 16, v116
    v_and_b32 v134, 0xffff0000, v116
    v_lshlrev_b32 v135, 16, v126
    v_and_b32 v136, 0xffff0000, v126
    v_mul_f32 v133, v133, v135
    v_mul_f32 v134, v134, v136
    v_cvt_pk_bf16_f32 v133, v133, v134
    v_and_b32 v134, 0xffff0000, v133
    v_lshlrev_b32 v133, 16, v133
    v_add_f32 v132, v132, v133
    v_add_f32 v132, v132, v134
    v_lshlrev_b32 v133, 16, v117
    v_and_b32 v134, 0xffff0000, v117
    v_lshlrev_b32 v135, 16, v127
    v_and_b32 v136, 0xffff0000, v127
    v_mul_f32 v133, v133, v135
    v_mul_f32 v134, v134, v136
    v_cvt_pk_bf16_f32 v133, v133, v134
    v_and_b32 v134, 0xffff0000, v133
    v_lshlrev_b32 v133, 16, v133
    v_add_f32 v132, v132, v133
    v_add_f32 v132, v132, v134
    v_lshlrev_b32 v133, 16, v118
    v_and_b32 v134, 0xffff0000, v118
    v_lshlrev_b32 v135, 16, v128
L_pad8:
    s_cbranch_execz L_pad9
    v_and_b32 v136, 0xffff0000, v128
    v_mul_f32 v133, v133, v135
    v_mul_f32 v134, v134, v136
    v_cvt_pk_bf16_f32 v133, v133, v134
    v_and_b32 v134, 0xffff0000, v133
    v_lshlrev_b32 v133, 16, v133
    v_add_f32 v132, v132, v133
    v_add_f32 v132, v132, v134
    v_lshlrev_b32 v133, 16, v119
    v_and_b32 v134, 0xffff0000, v119
    v_lshlrev_b32 v135, 16, v129
    v_and_b32 v136, 0xffff0000, v129
    v_mul_f32 v133, v133, v135
    v_mul_f32 v134, v134, v136
    v_cvt_pk_bf16_f32 v133, v133, v134
    v_and_b32 v134, 0xffff0000, v133
    v_lshlrev_b32 v133, 16, v133
    v_add_f32 v132, v132, v133
    v_add_f32 v132, v132, v134
    v_lshlrev_b32 v133, 16, v120
    v_and_b32 v134, 0xffff0000, v120
    v_lshlrev_b32 v135, 16, v130
    v_and_b32 v136, 0xffff0000, v130
    v_mul_f32 v133, v133, v135
    v_mul_f32 v134, v134, v136
    v_cvt_pk_bf16_f32 v133, v133, v134
    v_and_b32 v134, 0xffff0000, v133
    v_lshlrev_b32 v133, 16, v133
    v_add_f32 v132, v132, v133
    v_add_f32 v132, v132, v134
    s_nop 1
    v_add_f32_dpp v132, v132, v132 row_ror:1 row_mask:0xf bank_mask:0xf
    s_nop 1
    v_add_f32_dpp v132, v132, v132 row_ror:2 row_mask:0xf bank_mask:0xf
    s_nop 1
    v_add_f32_dpp v132, v132, v132 row_ror:4 row_mask:0xf bank_mask:0xf
    s_nop 1
    v_add_f32_dpp v132, v132, v132 row_ror:8 row_mask:0xf bank_mask:0xf
    v_mov_b32 v133, v132
    s_nop 1
    v_permlane16_swap_b32 v132, v133
    v_add_f32 v132, v132, v133
    v_cvt_pk_bf16_f32 v132, v132, v132
    v_lshlrev_b32 v132, 16, v132
    v_mul_f32 v132, s71, v132
    v_exp_f32 v132, -v132
L_pad9:
    s_cbranch_execz L_pad10
    s_nop 0
    v_add_f32 v132, 1.0, v132
    v_rcp_f32 v132, v132
    s_nop 0
    v_cvt_pk_bf16_f32 v132, v132, v132
    v_lshlrev_b32 v132, 16, v132
    v_sub_f32 v133, 1.0, v132
    v_cvt_pk_bf16_f32 v133, v133, v133
    v_lshlrev_b32 v133, 16, v133
    ds_write_b64 v96, v[132:133] offset:64
    v_and_b32 v106, 3, v0
    v_bfe_u32 v107, v0, 2, 1
    v_lshl_add_u32 v107, v107, 3, v106
    v_bfe_u32 v106, v0, 5, 1
    v_lshl_add_u32 v107, v106, 2, v107
    v_lshlrev_b32 v107, 2, v107
L_lw_4:
    ds_read_b32 v96, v1 offset:0
    s_sub_u32 s63, s63, 1
    s_cbranch_scc1 L_end
    s_waitcnt lgkmcnt(0)
    v_readfirstlane_b32 s3, v96
    s_cmp_lt_i32 s3, 52
    s_cbranch_scc1 L_lw_4
    buffer_load_dword v106, v107, s[28:31], 0 offen offset:128
    s_branch L_readychk
L_readywait:
    buffer_load_dword v106, v107, s[28:31], 0 offen offset:128 sc1
    s_sub_u32 s63, s63, 1
    s_cbranch_scc1 L_end
L_readychk:
    s_waitcnt vmcnt(0)
    v_cmp_le_i32 vcc, 0, v106
    s_cbranch_vccnz L_readywait
    v_mov_b32 v96, 1
    ds_write_b32 v1, v96 offset:40
    v_readlane_b32 s3, v106, s44
    v_bfe_u32 v106, v106, 4, 24
    s_and_b32 s3, s3, 15
    s_cmp_eq_u32 s3, s67
    s_cselect_b32 s9, 0, 0x2000
    s_cmp_eq_u32 s57, 7
    s_cselect_b32 s10, -2, 2
    s_cselect_b32 s17, -7, 2
    s_cselect_b32 s19, 8, 0
    s_add_u32 s18, s19, 0
    s_add_u32 s19, s19, 510
    s_lshl_b32 s11, s44, 1
    s_mov_b32 s12, 0
    s_mov_b32 s13, 0
    s_mov_b32 s14, 0
L_pad10:
    s_cbranch_execz L_pad11
    s_mov_b32 s15, 0
    s_and_b32 s46, s56, 167
L_ctl:
    ds_read_b32 v96, v1 offset:0
    s_sub_u32 s63, s63, 1
    s_cbranch_scc1 L_end
    s_waitcnt lgkmcnt(0)
    v_readfirstlane_b32 s8, v96
    s_cmp_le_i32 s8, s12
    s_cbranch_scc1 L_ctl
    s_mov_b32 s12, s8
    s_cmp_ge_i32 s8, s19
    s_cbranch_scc1 L_ctl_done
    s_cmp_eq_u32 s46, 0x80
    s_cbranch_scc1 L_coord
    s_cmp_lt_i32 s8, s9
    s_cbranch_scc1 L_ctl
    s_add_u32 s9, s8, 4
    s_mov_b64 exec, 1
    buffer_load_dword v97, off, s[4:7], s45 sc1
    s_mov_b64 exec, -1
    s_cmp_ge_i32 s8, 380
    s_cselect_b32 s10, s17, s10
    s_waitcnt vmcnt(0)
    v_readfirstlane_b32 s3, v97
    s_cmp_eq_u32 s3, 0
    s_cbranch_scc1 L_ctl
    s_sub_i32 s3, s3, s8
    s_sub_i32 s3, s3, s10
L_setw:
    s_ashr_i32 s3, s3, 1
    s_add_i32 s3, s3, 4
    s_max_i32 s3, s3, 0
    s_min_i32 s3, s3, 7
L_putw:
    v_mov_b32 v97, s3
    ds_write_b32 v1, v97 offset:52
    s_branch L_ctl
L_coord:
    s_add_i32 s3, s8, s13
    v_mov_b32 v97, s3
    s_mov_b64 exec, 1
    buffer_store_dword v97, off, s[4:7], s45
    s_cmp_lt_i32 s8, s11
    s_cbranch_scc1 L_nopub
    v_mov_b32 v96, s64
    s_mul_i32 s3, s11, 1024
    s_add_u32 s3, s3, 1048576
    buffer_store_dword v96, off, s[4:7], s3 sc1
    s_add_u32 s11, s11, 16
L_nopub:
    s_mov_b64 exec, -1
    s_cmp_eq_u32 s14, 0
    s_cbranch_scc1 L_idle
    s_sub_u32 s14, s14, 1
    s_cmp_lg_u32 s14, 0
    s_cbranch_scc1 L_ctl
    s_waitcnt vmcnt(5)
L_pad11:
    s_cbranch_execz L_pad12
    v_cmp_eq_u32 vcc, v106, v107
    s_and_b32 s3, vcc_lo, 16777215
    s_bcnt1_i32_b32 s3, s3
    s_lshl_b32 s3, s3, 1
    s_add_i32 s3, s3, s15
    s_mov_b32 s13, s3
    s_branch L_setw
L_idle:
    s_cmp_lt_i32 s8, s9
    s_cbranch_scc1 L_ctl
    s_add_u32 s9, s8, 6
    s_cmp_lt_i32 s8, 64
    s_cbranch_scc1 L_ctl
    s_mov_b32 s14, 5
    s_sub_i32 s15, s8, 23
    s_lshr_b32 s15, s15, 1
    s_min_i32 s15, s15, 232
    v_subrev_u32 v108, s15, v0
    v_bfi_b32 v108, 7, v108, v0
    v_add_u32 v108, s15, v108
    v_mul_u32_u24 v108, 2048, v108
    s_mov_b32 s3, 1048576
    s_mov_b32 exec_hi, 0
    s_mov_b32 exec_lo, 16777215
    buffer_load_dword v107, v108, s[4:7], s3 offen sc1
    s_mov_b64 exec, -1
    s_lshl_b32 s15, s15, 1
    s_sub_i32 s15, s15, s8
    s_sub_i32 s15, s15, 1
    s_branch L_ctl
L_fastmiss:
    s_and_b32 s3, s70, 3
    s_cbranch_scc1 L_fastwait
    s_cmp_lg_u32 s47, 0
    s_cbranch_scc1 L_fastchk
    s_mov_b32 s47, 7
    s_mov_b64 exec, 1
    buffer_store_dword v98, off, s[28:31], s77 offset:128 sc1
L_fastchk:
    s_mov_b32 exec_lo, 0xffff
    s_mov_b32 exec_hi, 0xffff
    buffer_load_dword v97, v13, s[4:7], s74 offen sc1
    s_waitcnt vmcnt(0)
    v_cmp_eq_u32 vcc, s64, v97
    s_cmp_eq_u32 vcc_hi, 0xffff
    s_cbranch_scc1 L_flags_ok
    s_cmp_eq_u32 vcc_lo, 0
    s_cbranch_scc1 L_fastwait
L_goslow:
    s_mov_b32 s65, 1
    s_cmp_lg_u32 s47, 0
    s_cbranch_scc1 L_noann
    s_mov_b64 exec, 1
    buffer_store_dword v98, off, s[28:31], s77 offset:128 sc1
L_noann:
L_pad12:
    s_cbranch_execz L_pad13
    s_mov_b64 exec, -1
    buffer_store_dwordx4 v[20:23], v12, s[4:7], s69 offen sc1
    s_mov_b32 exec_hi, 0xff
    buffer_store_dwordx4 v[24:27], v15, s[4:7], s59 offen sc1
    buffer_store_dwordx4 v[24:27], v15, s[4:7], s75 offen sc1
    s_mov_b64 exec, 1
    s_waitcnt vmcnt(0)
    buffer_store_dword v101, off, s[4:7], s76 sc1
    s_mov_b64 exec, 0xffff
L_slowwait:
    buffer_load_dword v97, v13, s[4:7], s74 offen sc1
    s_sub_u32 s63, s63, 1
    s_cbranch_scc1 L_end
    s_waitcnt vmcnt(0)
    v_cmp_ne_u32 vcc, s64, v97
    s_cbranch_vccnz L_slowwait
    s_branch L_flags_ok
L_noproj:
    s_waitcnt lgkmcnt(0)
    s_barrier
    v_and_b32 v96, 1, v0
    v_cmp_eq_u32 vcc, 1, v96
    v_mov_b32 v97, 0x0c0c0100
    v_mov_b32 v98, 0x01000c0c
    v_cndmask_b32 v97, v97, v98, vcc
    v_mov_b32 v98, 0x0c0c0302
    v_mov_b32 v99, 0x03020c0c
    v_cndmask_b32 v98, v98, v99, vcc
    v_bfe_u32 v96, v0, 1, 2
    v_mov_b32 v99, 0x0c0c0c0c
    v_cmp_eq_u32 vcc, 0, v96
    s_nop 1
    v_cndmask_b32 v4, v99, v97, vcc
    v_cndmask_b32 v8, v99, v98, vcc
    v_cmp_eq_u32 vcc, 1, v96
    s_nop 1
    v_cndmask_b32 v5, v99, v97, vcc
    v_cndmask_b32 v9, v99, v98, vcc
    v_cmp_eq_u32 vcc, 2, v96
    s_nop 1
    v_cndmask_b32 v6, v99, v97, vcc
    v_cndmask_b32 v10, v99, v98, vcc
    v_cmp_eq_u32 vcc, 3, v96
    s_nop 1
    v_cndmask_b32 v7, v99, v97, vcc
    v_cndmask_b32 v11, v99, v98, vcc
L_qwait:
    s_mov_b64 s[4:5], s[54:55]
    v_lshrrev_b32 v98, 5, v0
    v_and_b32 v97, 1, v2
    v_lshlrev_b32 v96, 12, v98
    v_lshl_add_u32 v96, v3, 8, v96
L_pad13:
    s_cbranch_execz L_pad14
    v_lshl_add_u32 v12, v97, 3, v96
    v_mul_u32_u24 v96, 9, v98
    v_add_u32 v96, v96, v97
    v_mul_u32_u24 v96, 8192, v96
    v_lshl_add_u32 v18, v3, 2, v96
    s_mul_i32 s79, s60, 128
    s_lshl_b32 s3, s58, 6
    s_add_u32 s79, s79, s3
    s_lshl_b32 s3, s57, 2
    s_add_u32 s3, s3, s62
    s_mul_i32 s3, s3, 2048
    s_add_u32 s79, s79, s3
    s_add_u32 s79, s79, 2097152
    s_cmp_eq_u32 s57, 7
    s_cselect_b32 s47, -1, 0xffff
    s_mov_b32 exec_lo, s47
    s_mov_b32 exec_hi, s47
    buffer_load_dword v114, v18, s[4:7], s79 offen sc1
    s_mov_b64 exec, -1
    s_lshl_b32 s3, s58, 3
    s_add_u32 s3, s3, s57
    s_lshl_b32 s3, s3, 3
    s_mul_i32 s76, s60, 10240
    s_add_u32 s59, s76, s3
    s_add_u32 s46, s59, 8192
    s_add_u32 s59, s59, s3
    s_lshl_b32 s77, s58, 7
    s_add_u32 s77, s77, s76
    s_add_u32 s77, s77, 8192
    s_lshl_b32 s3, s58, 12
    s_add_u32 s76, s76, s3
    v_lshlrev_b32 v116, 4, v0
    v_lshlrev_b32 v115, 2, v0
    s_lshl_b32 s3, s62, 10
    v_add_u32 v120, s3, v116
    v_lshrrev_b32 v121, 2, v120
    v_lshl_add_u32 v96, v97, 2, v3
    v_and_b32 v96, 7, v96
    v_lshl_add_u32 v96, v98, 3, v96
    v_lshlrev_b32 v117, 3, v96
    v_lshlrev_b32 v126, 3, v98
    v_lshlrev_b32 v119, 4, v3
    v_lshrrev_b32 v96, 2, v3
    v_lshl_add_u32 v98, v2, 3, v96
    v_bfe_u32 v99, v0, 1, 1
    v_and_b32 v100, 1, v0
    v_lshlrev_b32 v100, 3, v100
    s_lshl_b32 s3, s62, 12
L_pad14:
    s_cbranch_execz L_pad15
    v_subrev_u32 v100, s3, v100
    v_lshrrev_b32 v96, 1, v96
    v_lshl_add_u32 v101, v97, 1, v96
    v_lshlrev_b32 v101, 1, v101
    s_lshl_b32 s3, s62, 1
    v_add_u32 v102, s3, v99
    v_xor_b32 v101, v101, v102
    v_lshl_add_u32 v103, v98, 7, v100
    v_lshl_add_u32 v118, v101, 4, v103
    v_xor_b32 v96, v2, v3
    v_lshlrev_b32 v96, 4, v96
    v_lshl_add_u32 v13, v3, 8, v96
    v_xor_b32 v14, 64, v13
    v_xor_b32 v15, 0x80, v13
    v_xor_b32 v16, 64, v15
    v_lshl_add_u32 v17, v2, 10, v119
    v_mov_b32 v94, 0
    v_mov_b32 v113, 1
    v_mov_b32 v124, 0
    v_mov_b32 v125, 0
    s_lshl_b32 s3, s62, 2
    v_mov_b32 v95, s3
    s_lshl_b32 s3, s62, 11
    v_lshrrev_b32 v96, 3, v0
    v_lshl_add_u32 v19, v96, 3, s3
    s_lshl_b32 s64, s62, 12
    s_add_u32 s74, s64, 163840
    s_add_u32 s64, s64, 16384
    s_mov_b32 s75, s64
    s_add_u32 s65, s62, 1
    s_mov_b32 s66, 0
    s_mov_b32 s68, 0
    s_mov_b32 s40, 3
    s_mov_b32 s41, 4
    s_mov_b32 s70, 0x3db504f3
    v_lshrrev_b32 v96, 3, v3
    v_lshlrev_b32 v96, 8, v96
    v_lshl_add_u32 v112, v2, 4, v96
    v_add_u32 v100, s64, v13
    v_add_u32 v101, s64, v14
    v_add_u32 v102, s64, v15
    v_add_u32 v103, s64, v16
    s_cmp_ge_i32 s68, s65
    s_cbranch_scc1 L_pd_8
L_pl_7:
    ds_read_b32 v96, v1 offset:0
    s_sub_u32 s63, s63, 1
    s_cbranch_scc1 L_end
    s_waitcnt lgkmcnt(0)
    v_readfirstlane_b32 s68, v96
    s_cmp_lt_i32 s68, s65
    s_cbranch_scc1 L_pl_7
L_pd_8:
L_pad15:
    s_cbranch_execz L_pad16
    ds_read_b128 v[144:147], v100
    ds_read_b128 v[148:151], v101
    ds_read_b128 v[152:155], v102
    ds_read_b128 v[156:159], v103
    s_add_u32 s65, s65, 4
    s_addk_i32 s64, 0x4000
    s_cmp_eq_u32 s64, s74
    s_cselect_b32 s64, s75, s64
    v_add_u32 v94, 1, v94
    s_add_u32 s66, s66, 1
    s_waitcnt lgkmcnt(0)
    ds_write_b32 v95, v94 offset:16
    v_add_u32 v100, s64, v13
    v_add_u32 v101, s64, v14
    v_add_u32 v102, s64, v15
    v_add_u32 v103, s64, v16
    s_cmp_ge_i32 s68, s65
    s_cbranch_scc1 L_pd_10
L_pl_9:
    ds_read_b32 v96, v1 offset:0
    s_sub_u32 s63, s63, 1
    s_cbranch_scc1 L_end
    s_waitcnt lgkmcnt(0)
    v_readfirstlane_b32 s68, v96
    s_cmp_lt_i32 s68, s65
    s_cbranch_scc1 L_pl_9
L_pd_10:
    ds_read_b128 v[160:163], v100
    ds_read_b128 v[164:167], v101
    ds_read_b128 v[168:171], v102
    ds_read_b128 v[172:175], v103
    s_add_u32 s65, s65, 4
    s_addk_i32 s64, 0x4000
    s_cmp_eq_u32 s64, s74
    s_cselect_b32 s64, s75, s64
    v_add_u32 v94, 1, v94
    s_add_u32 s66, s66, 1
    s_waitcnt lgkmcnt(0)
    ds_write_b32 v95, v94 offset:16
L_lw_11:
    ds_read_b32 v96, v1 offset:36
    s_sub_u32 s63, s63, 1
    s_cbranch_scc1 L_end
    s_waitcnt lgkmcnt(0)
    v_readfirstlane_b32 s69, v96
    s_cmp_eq_u32 s69, 0
    s_cbranch_scc1 L_lw_11
    ds_read_b128 v[20:23], v112 offset:7168
    ds_read_b128 v[24:27], v112 offset:7232
    ds_read_b128 v[28:31], v112 offset:7296
    ds_read_b128 v[32:35], v112 offset:7360
L_pad16:
    s_cbranch_execz L_pad17
    v_add_u32 v112, 512, v112
    v_mov_b32 v92, 0xff800000
    s_mov_b32 s67, 32
    s_waitcnt lgkmcnt(0)
    v_mfma_f32_16x16x32_bf16 v[68:71], v[144:147], v[20:23], 0
    v_mfma_f32_16x16x32_bf16 v[68:71], v[148:151], v[24:27], v[68:71]
    v_mfma_f32_16x16x32_bf16 v[68:71], v[152:155], v[28:31], v[68:71]
    v_mfma_f32_16x16x32_bf16 v[68:71], v[156:159], v[32:35], v[68:71]
    s_nop 7
    v_cvt_pk_bf16_f32 v96, v68, v69
    v_cvt_pk_bf16_f32 v97, v70, v71
    v_lshlrev_b32 v68, 16, v96
    v_and_b32 v69, 0xffff0000, v96
    v_lshlrev_b32 v70, 16, v97
    v_and_b32 v71, 0xffff0000, v97
    v_mul_f32 v68, s70, v68
    v_mul_f32 v69, s70, v69
    v_mul_f32 v70, s70, v70
    v_mul_f32 v71, s70, v71
    v_cvt_pk_bf16_f32 v98, v68, v69
    v_cvt_pk_bf16_f32 v99, v70, v71
    v_max3_f32 v92, v92, v68, v69
    v_max3_f32 v92, v92, v70, v71
    ds_write_b64 v19, v[98:99] offset:8192
    v_add_u32 v19, 64, v19
    v_mfma_f32_16x16x32_bf16 v[68:71], v[160:163], v[20:23], 0
    v_mfma_f32_16x16x32_bf16 v[68:71], v[164:167], v[24:27], v[68:71]
    v_mfma_f32_16x16x32_bf16 v[68:71], v[168:171], v[28:31], v[68:71]
    v_mfma_f32_16x16x32_bf16 v[68:71], v[172:175], v[32:35], v[68:71]
    s_nop 7
    v_cvt_pk_bf16_f32 v96, v68, v69
    v_cvt_pk_bf16_f32 v97, v70, v71
    v_lshlrev_b32 v68, 16, v96
    v_and_b32 v69, 0xffff0000, v96
    v_lshlrev_b32 v70, 16, v97
    v_and_b32 v71, 0xffff0000, v97
    v_mul_f32 v68, s70, v68
    v_mul_f32 v69, s70, v69
    v_mul_f32 v70, s70, v70
L_pad17:
    s_cbranch_execz L_pad18
    v_mul_f32 v71, s70, v71
    v_cvt_pk_bf16_f32 v98, v68, v69
    v_cvt_pk_bf16_f32 v99, v70, v71
    v_max3_f32 v92, v92, v68, v69
    v_max3_f32 v92, v92, v70, v71
    ds_write_b64 v19, v[98:99] offset:8192
    v_add_u32 v19, 64, v19
    s_branch L_kpass
L_branch:
    ds_read_b128 v[20:23], v112 offset:7168
    ds_read_b128 v[24:27], v112 offset:7232
    ds_read_b128 v[28:31], v112 offset:7296
    ds_read_b128 v[32:35], v112 offset:7360
    v_add_u32 v112, 512, v112
    v_mov_b32 v92, 0xff800000
    s_add_u32 s67, s66, 32
    s_waitcnt lgkmcnt(0)
L_kpass:
    v_add_u32 v100, s64, v13
    v_add_u32 v101, s64, v14
    v_add_u32 v102, s64, v15
    v_add_u32 v103, s64, v16
    s_cmp_ge_i32 s68, s65
    s_cbranch_scc1 L_pd_13
L_pl_12:
    ds_read_b32 v96, v1 offset:0
    s_sub_u32 s63, s63, 1
    s_cbranch_scc1 L_end
    s_waitcnt lgkmcnt(0)
    v_readfirstlane_b32 s68, v96
    s_cmp_lt_i32 s68, s65
    s_cbranch_scc1 L_pl_12
L_pd_13:
    ds_read_b128 v[36:39], v100
    ds_read_b128 v[40:43], v101
    ds_read_b128 v[44:47], v102
    ds_read_b128 v[48:51], v103
    s_add_u32 s65, s65, 4
    s_addk_i32 s64, 0x4000
    s_cmp_eq_u32 s64, s74
    s_cselect_b32 s64, s75, s64
    v_add_u32 v94, 1, v94
    s_add_u32 s66, s66, 1
    s_waitcnt lgkmcnt(3)
    v_mfma_f32_16x16x32_bf16 v[68:71], v[36:39], v[20:23], 0
    s_waitcnt lgkmcnt(2)
    v_mfma_f32_16x16x32_bf16 v[68:71], v[40:43], v[24:27], v[68:71]
    s_waitcnt lgkmcnt(1)
    v_mfma_f32_16x16x32_bf16 v[68:71], v[44:47], v[28:31], v[68:71]
L_pad18:
    s_cbranch_execz L_pad19
    s_waitcnt lgkmcnt(0)
    v_mfma_f32_16x16x32_bf16 v[68:71], v[48:51], v[32:35], v[68:71]
    ds_write_b32 v95, v94 offset:16
    s_nop 6
    v_cvt_pk_bf16_f32 v96, v68, v69
    v_cvt_pk_bf16_f32 v97, v70, v71
    v_lshlrev_b32 v68, 16, v96
    v_and_b32 v69, 0xffff0000, v96
    v_lshlrev_b32 v70, 16, v97
    v_and_b32 v71, 0xffff0000, v97
    v_mul_f32 v68, s70, v68
    v_mul_f32 v69, s70, v69
    v_mul_f32 v70, s70, v70
    v_mul_f32 v71, s70, v71
    v_cvt_pk_bf16_f32 v98, v68, v69
    v_cvt_pk_bf16_f32 v99, v70, v71
    v_max3_f32 v92, v92, v68, v69
    v_max3_f32 v92, v92, v70, v71
    ds_write_b64 v19, v[98:99] offset:8192
    v_add_u32 v19, 64, v19
    s_cmp_lt_u32 s66, s67
    s_cbranch_scc1 L_kpass
    v_mov_b32 v96, v92
    s_nop 1
    v_permlane16_swap_b32 v92, v96
    v_max_f32 v92, v92, v96
    v_mov_b32 v96, v92
    s_nop 1
    v_permlane32_swap_b32 v92, v96
    v_max_f32 v92, v92, v96
    ds_write_b32 v121, v92 offset:6144
    s_mov_b64 exec, 1
    ds_add_u32 v1, v113 offset:48
    s_mov_b64 exec, -1
    v_subrev_u32 v19, 2048, v19
    s_add_u32 s67, s66, 31
    v_mov_b32 v88, 0
    v_mov_b32 v89, 0
    v_mov_b32 v90, 0
    v_mov_b32 v91, 0
    v_mov_b32 v93, 0
L_lw_14:
    ds_read_b32 v96, v1 offset:48
    s_sub_u32 s63, s63, 1
    s_cbranch_scc1 L_end
    s_waitcnt lgkmcnt(0)
    v_readfirstlane_b32 s3, v96
    s_cmp_lt_u32 s3, s41
L_pad19:
    s_cbranch_execz L_pad20
    s_cbranch_scc1 L_lw_14
    ds_read2st64_b32 v[96:97], v115 offset0:24 offset1:25
    ds_read2st64_b32 v[98:99], v115 offset0:26 offset1:27
    s_add_u32 s41, s41, 4
    s_waitcnt lgkmcnt(0)
    v_max3_f32 v92, v96, v97, v98
    v_max_f32 v92, v92, v99
    v_cvt_pk_bf16_f32 v92, v92, v92
    v_and_b32 v92, 0xffff0000, v92
    v_max_f32 v92, 0xff7fffff, v92
    s_cmp_eq_u32 s66, 96
    s_cbranch_scc1 L_prep
L_vpass:
    ds_read_b64 v[98:99], v19 offset:8192
    v_add_u32 v19, 64, v19
    v_add_u32 v100, s64, v17
    s_waitcnt lgkmcnt(0)
    v_lshlrev_b32 v68, 16, v98
    v_and_b32 v69, 0xffff0000, v98
    v_lshlrev_b32 v70, 16, v99
    v_and_b32 v71, 0xffff0000, v99
    v_sub_f32 v68, v68, v92
    v_sub_f32 v69, v69, v92
    v_sub_f32 v70, v70, v92
    v_sub_f32 v71, v71, v92
    v_mul_f32 v68, s71, v68
    v_mul_f32 v69, s71, v69
    v_mul_f32 v70, s71, v70
    v_mul_f32 v71, s71, v71
    v_exp_f32 v68, v68
    v_exp_f32 v69, v69
    v_exp_f32 v70, v70
    v_exp_f32 v71, v71
    v_cvt_pk_bf16_f32 v98, v68, v69
    v_cvt_pk_bf16_f32 v99, v70, v71
    v_add_f32 v68, v68, v69
    v_add_f32 v70, v70, v71
    v_add_f32 v68, v68, v70
    v_add_f32 v93, v93, v68
    v_perm_b32 v72, v98, v98, v4
    v_perm_b32 v73, v98, v98, v5
    v_perm_b32 v74, v98, v98, v6
    v_perm_b32 v75, v98, v98, v7
    v_perm_b32 v76, v98, v98, v8
    v_perm_b32 v77, v98, v98, v9
    v_perm_b32 v78, v98, v98, v10
L_pad20:
    s_cbranch_execz L_pad21
    v_perm_b32 v79, v98, v98, v11
    v_perm_b32 v80, v99, v99, v4
    v_perm_b32 v81, v99, v99, v5
    v_perm_b32 v82, v99, v99, v6
    v_perm_b32 v83, v99, v99, v7
    v_perm_b32 v84, v99, v99, v8
    v_perm_b32 v85, v99, v99, v9
    v_perm_b32 v86, v99, v99, v10
    v_perm_b32 v87, v99, v99, v11
    s_cmp_eq_u32 s66, s67
    s_cbranch_scc1 L_vlast
    s_cmp_ge_i32 s68, s65
    s_cbranch_scc1 L_pd_16
L_pl_15:
    ds_read_b32 v96, v1 offset:0
    s_sub_u32 s63, s63, 1
    s_cbranch_scc1 L_end
    s_waitcnt lgkmcnt(0)
    v_readfirstlane_b32 s68, v96
    s_cmp_lt_i32 s68, s65
    s_cbranch_scc1 L_pl_15
L_pd_16:
    ds_read_b128 v[52:55], v100 offset:0
    ds_read_b128 v[56:59], v100 offset:256
    ds_read_b128 v[60:63], v100 offset:512
    ds_read_b128 v[64:67], v100 offset:768
    s_add_u32 s65, s65, 4
    s_addk_i32 s64, 0x4000
    s_cmp_eq_u32 s64, s74
    s_cselect_b32 s64, s75, s64
    v_add_u32 v94, 1, v94
    s_add_u32 s66, s66, 1
    s_waitcnt lgkmcnt(3)
    v_mfma_f32_16x16x32_bf16 v[88:91], v[72:75], v[52:55], v[88:91]
    s_waitcnt lgkmcnt(2)
    v_mfma_f32_16x16x32_bf16 v[88:91], v[76:79], v[56:59], v[88:91]
    s_waitcnt lgkmcnt(1)
    v_mfma_f32_16x16x32_bf16 v[88:91], v[80:83], v[60:63], v[88:91]
    s_waitcnt lgkmcnt(0)
    v_mfma_f32_16x16x32_bf16 v[88:91], v[84:87], v[64:67], v[88:91]
    ds_write_b32 v95, v94 offset:16
    s_branch L_vpass
L_vlast:
    v_mov_b32 v97, v93
    s_nop 1
    v_permlane16_swap_b32 v93, v97
L_pad21:
    s_cbranch_execz L_pad22
    v_add_f32 v93, v93, v97
    v_mov_b32 v97, v93
    s_nop 1
    v_permlane32_swap_b32 v93, v97
    v_add_f32 v93, v93, v97
    v_subrev_u32 v19, 2048, v19
    s_cmp_eq_u32 s62, 3
    s_cbranch_scc1 L_vlast3
    ds_write_b32 v121, v93 offset:5120
    s_cmp_ge_i32 s68, s65
    s_cbranch_scc1 L_pd_18
L_pl_17:
    ds_read_b32 v96, v1 offset:0
    s_sub_u32 s63, s63, 1
    s_cbranch_scc1 L_end
    s_waitcnt lgkmcnt(0)
    v_readfirstlane_b32 s68, v96
    s_cmp_lt_i32 s68, s65
    s_cbranch_scc1 L_pl_17
L_pd_18:
    ds_read_b128 v[52:55], v100 offset:0
    ds_read_b128 v[56:59], v100 offset:256
    ds_read_b128 v[60:63], v100 offset:512
    ds_read_b128 v[64:67], v100 offset:768
    s_waitcnt lgkmcnt(3)
    v_mfma_f32_16x16x32_bf16 v[88:91], v[72:75], v[52:55], v[88:91]
    s_waitcnt lgkmcnt(2)
    v_mfma_f32_16x16x32_bf16 v[88:91], v[76:79], v[56:59], v[88:91]
    s_waitcnt lgkmcnt(1)
    v_mfma_f32_16x16x32_bf16 v[88:91], v[80:83], v[60:63], v[88:91]
    s_waitcnt lgkmcnt(0)
    v_mfma_f32_16x16x32_bf16 v[88:91], v[84:87], v[64:67], v[88:91]
    s_add_u32 s65, s65, 4
    s_addk_i32 s64, 0x4000
    s_cmp_eq_u32 s64, s74
    s_cselect_b32 s64, s75, s64
    v_add_u32 v94, 1, v94
    s_add_u32 s66, s66, 1
    ds_write_b32 v95, v94 offset:16
    s_nop 0
    ds_write_b128 v120, v[88:91] offset:1024
    s_mov_b64 exec, 1
    ds_add_u32 v1, v113 offset:44
    s_mov_b64 exec, -1
    s_branch L_flushed
L_vlast3:
    s_cmp_ge_i32 s68, s65
    s_cbranch_scc1 L_pd_20
L_pl_19:
    ds_read_b32 v96, v1 offset:0
    s_sub_u32 s63, s63, 1
    s_cbranch_scc1 L_end
L_pad22:
    s_cbranch_execz L_pad23
    s_waitcnt lgkmcnt(0)
    v_readfirstlane_b32 s68, v96
    s_cmp_lt_i32 s68, s65
    s_cbranch_scc1 L_pl_19
L_pd_20:
    ds_read_b128 v[52:55], v100 offset:0
    ds_read_b128 v[56:59], v100 offset:256
    ds_read_b128 v[60:63], v100 offset:512
    ds_read_b128 v[64:67], v100 offset:768
    ds_read_b32 v101, v1 offset:44
    ds_read_b128 v[36:39], v116 offset:1024
    ds_read_b128 v[40:43], v116 offset:2048
    ds_read_b128 v[44:47], v116 offset:3072
    ds_read2st64_b32 v[102:103], v115 offset0:20 offset1:21
    ds_read_b32 v104, v115 offset:5632
    s_waitcnt lgkmcnt(9)
    v_mfma_f32_16x16x32_bf16 v[88:91], v[72:75], v[52:55], v[88:91]
    s_waitcnt lgkmcnt(8)
    v_mfma_f32_16x16x32_bf16 v[88:91], v[76:79], v[56:59], v[88:91]
    s_waitcnt lgkmcnt(7)
    v_mfma_f32_16x16x32_bf16 v[88:91], v[80:83], v[60:63], v[88:91]
    s_waitcnt lgkmcnt(6)
    v_mfma_f32_16x16x32_bf16 v[88:91], v[84:87], v[64:67], v[88:91]
    s_add_u32 s65, s65, 4
    s_addk_i32 s64, 0x4000
    s_cmp_eq_u32 s64, s74
    s_cselect_b32 s64, s75, s64
    v_add_u32 v94, 1, v94
    s_add_u32 s66, s66, 1
    ds_write_b32 v95, v94 offset:16
L_join3:
    s_waitcnt lgkmcnt(0)
    v_readfirstlane_b32 s3, v101
    s_cmp_lt_u32 s3, s40
    s_cbranch_scc1 L_retry3
    v_add_f32 v36, v36, v40
    v_add_f32 v37, v37, v41
    v_add_f32 v38, v38, v42
    v_add_f32 v39, v39, v43
    v_add_f32 v44, v44, v88
    v_add_f32 v45, v45, v89
    v_add_f32 v46, v46, v90
    v_add_f32 v47, v47, v91
    v_add_f32 v36, v36, v44
    v_add_f32 v37, v37, v45
    v_add_f32 v38, v38, v46
    v_add_f32 v39, v39, v47
    v_cvt_pk_bf16_f32 v36, v36, v37
    v_cvt_pk_bf16_f32 v37, v38, v39
L_pad23:
    s_cbranch_execz L_pad24
    s_cmp_eq_u32 s69, 2
    v_min_u32 v36, -2, v36
    v_min_u32 v37, -2, v37
    s_cbranch_scc1 L_flush_slow
    buffer_store_dwordx2 v[36:37], v12, s[4:7], s59 offen
    v_add_f32 v102, v102, v103
    v_add_f32 v93, v104, v93
    v_add_f32 v93, v102, v93
    s_mov_b64 exec, 0x101
    v_min_u32 v93, -2, v93
    buffer_store_dwordx2 v[92:93], v119, s[4:7], s46 offen
    s_mov_b64 exec, -1
L_flush_done:
L_flushed:
    s_cmp_lt_u32 s66, 128
    s_cbranch_scc1 L_nextbr
L_proj:
    buffer_load_dwordx2 v[122:123], v117, s[4:7], s77 offen sc1
    buffer_load_dwordx4 v[20:23], v116, s[4:7], s76 offen offset:0 sc1
    buffer_load_dwordx4 v[24:27], v116, s[4:7], s76 offen offset:1024 sc1
    buffer_load_dwordx4 v[28:31], v116, s[4:7], s76 offen offset:2048 sc1
    buffer_load_dwordx4 v[32:35], v116, s[4:7], s76 offen offset:3072 sc1
    s_sub_u32 s72, s65, s62
    s_add_u32 s72, s72, 3
    v_add_u32 v104, s64, v118
    s_cmp_ge_i32 s68, s72
    s_cbranch_scc1 L_pd_22
L_pl_21:
    ds_read_b32 v96, v1 offset:0
    s_sub_u32 s63, s63, 1
    s_cbranch_scc1 L_end
    s_waitcnt lgkmcnt(0)
    v_readfirstlane_b32 s68, v96
    s_cmp_lt_i32 s68, s72
    s_cbranch_scc1 L_pl_21
L_pd_22:
    ds_read_b64_tr_b16 v[144:145], v104 offset:0
    ds_read_b64_tr_b16 v[146:147], v104 offset:512
    ds_read_b64_tr_b16 v[148:149], v104 offset:4096
    ds_read_b64_tr_b16 v[150:151], v104 offset:4608
    ds_read_b64_tr_b16 v[152:153], v104 offset:8192
    ds_read_b64_tr_b16 v[154:155], v104 offset:8704
    ds_read_b64_tr_b16 v[156:157], v104 offset:12288
    ds_read_b64_tr_b16 v[158:159], v104 offset:12800
    s_add_u32 s65, s65, 4
    s_addk_i32 s64, 0x4000
    s_cmp_eq_u32 s64, s74
    s_cselect_b32 s64, s75, s64
    v_add_u32 v94, 1, v94
L_pad24:
    s_cbranch_execz L_pad25
    s_branch L_h1_chk
L_h1:
    buffer_load_dwordx2 v[122:123], v117, s[4:7], s77 offen sc1
    buffer_load_dwordx4 v[20:23], v116, s[4:7], s76 offen offset:0 sc1
    buffer_load_dwordx4 v[24:27], v116, s[4:7], s76 offen offset:1024 sc1
    buffer_load_dwordx4 v[28:31], v116, s[4:7], s76 offen offset:2048 sc1
    buffer_load_dwordx4 v[32:35], v116, s[4:7], s76 offen offset:3072 sc1
    s_sub_u32 s63, s63, 1
    s_cbranch_scc1 L_end
L_h1_chk:
    s_waitcnt vmcnt(0)
    v_max3_u32 v96, v122, v123, v35
    v_max3_u32 v97, v20, v21, v22
    v_max3_u32 v98, v23, v24, v25
    v_max3_u32 v99, v26, v27, v28
    v_max3_u32 v100, v29, v30, v31
    v_max3_u32 v101, v32, v33, v34
    v_max3_u32 v96, v96, v97, v98
    v_max3_u32 v99, v99, v100, v101
    v_max_u32 v96, v96, v99
    v_cmp_eq_u32 vcc, -1, v96
    s_mov_b64 exec, vcc
    s_cbranch_execnz L_h1
    s_mov_b64 exec, -1
    s_waitcnt lgkmcnt(0)
    v_max_f32_dpp v96, v122, v122 quad_perm:[1,0,3,2] row_mask:0xf bank_mask:0xf
    v_mfma_f32_16x16x32_bf16 v[56:59], v[20:23], v[144:147], 0
    s_cmp_lg_u32 s57, 7
    v_max_f32_dpp v97, v96, v96 quad_perm:[2,3,0,1] row_mask:0xf bank_mask:0xf
    v_mfma_f32_16x16x32_bf16 v[56:59], v[24:27], v[148:151], v[56:59]
    s_nop 0
    v_max_f32_dpp v96, v97, v97 row_half_mirror row_mask:0xf bank_mask:0xf
    v_sub_f32 v96, v122, v96
    v_mul_f32 v96, s71, v96
    v_exp_f32 v96, v96
    v_mfma_f32_16x16x32_bf16 v[56:59], v[28:31], v[152:155], v[56:59]
    v_mul_f32 v97, v96, v123
    v_mfma_f32_16x16x32_bf16 v[56:59], v[32:35], v[156:159], v[56:59]
    v_mul_f32 v96, v126, v96
    s_cbranch_scc1 L_narrow
    v_mfma_f32_16x16x32_bf16 v[60:63], v[20:23], v[160:163], 0
    v_mfma_f32_16x16x32_bf16 v[60:63], v[24:27], v[164:167], v[60:63]
    v_mfma_f32_16x16x32_bf16 v[60:63], v[28:31], v[168:171], v[60:63]
L_pad25:
    s_cbranch_execz L_pad26
    v_mfma_f32_16x16x32_bf16 v[60:63], v[32:35], v[172:175], v[60:63]
L_narrow:
    v_add_f32_dpp v97, v97, v97 quad_perm:[1,0,3,2] row_mask:0xf bank_mask:0xf
    s_nop 1
    v_add_f32_dpp v97, v97, v97 quad_perm:[2,3,0,1] row_mask:0xf bank_mask:0xf
    s_nop 1
    v_add_f32_dpp v97, v97, v97 row_half_mirror row_mask:0xf bank_mask:0xf
    v_rcp_f32 v97, v97
    s_cmp_lt_u32 s66, 128
    v_mul_f32 v96, v96, v97
    s_nop 1
    v_mul_f32_dpp v56, v96, v56 row_newbcast:0 row_mask:0xf bank_mask:0xf
    v_mul_f32_dpp v57, v96, v57 row_newbcast:1 row_mask:0xf bank_mask:0xf
    v_mul_f32_dpp v58, v96, v58 row_newbcast:2 row_mask:0xf bank_mask:0xf
    v_mul_f32_dpp v59, v96, v59 row_newbcast:3 row_mask:0xf bank_mask:0xf
    v_mul_f32_dpp v60, v96, v60 row_newbcast:0 row_mask:0xf bank_mask:0xf
    v_mul_f32_dpp v61, v96, v61 row_newbcast:1 row_mask:0xf bank_mask:0xf
    v_mul_f32_dpp v62, v96, v62 row_newbcast:2 row_mask:0xf bank_mask:0xf
    v_mul_f32_dpp v63, v96, v63 row_newbcast:3 row_mask:0xf bank_mask:0xf
    v_add_f32 v56, v56, v57
    v_add_f32 v60, v60, v61
    v_add_f32 v58, v58, v59
    v_add_f32 v62, v62, v63
    v_add_f32 v124, v124, v56
    v_add_f32 v125, v125, v60
    v_add_f32 v124, v124, v58
    v_add_f32 v125, v125, v62
    s_cbranch_scc1 L_projA_done
    s_nop 0
    v_permlane16_swap_b32 v124, v125
    v_add_f32 v124, v124, v125
    s_mov_b32 exec_lo, s47
    s_mov_b32 exec_hi, s47
    v_bfi_b32 v124, 1, v114, v124
    buffer_store_dword v124, v18, s[4:7], s79 offen sc1
    s_waitcnt vmcnt(0)
    s_barrier
    s_branch L_end
L_nextbr:
    s_add_u32 s59, s59, 163840
    s_add_u32 s46, s46, 163840
    s_add_u32 s40, s40, 3
    s_branch L_branch
L_retry3:
    s_sub_u32 s63, s63, 1
    s_cbranch_scc1 L_end
    ds_read_b32 v101, v1 offset:44
L_pad26:
    s_cbranch_execz L_pad27
    ds_read_b128 v[36:39], v116 offset:1024
    ds_read_b128 v[40:43], v116 offset:2048
    ds_read_b128 v[44:47], v116 offset:3072
    ds_read2st64_b32 v[102:103], v115 offset0:20 offset1:21
    ds_read_b32 v104, v115 offset:5632
    s_branch L_join3
L_prep:
L_lw_23:
    ds_read_b32 v96, v1 offset:40
    s_sub_u32 s63, s63, 1
    s_cbranch_scc1 L_end
    s_waitcnt lgkmcnt(0)
    v_readfirstlane_b32 s3, v96
    s_cmp_eq_u32 s3, 0
    s_cbranch_scc1 L_lw_23
    ds_read_b64 v[126:127], v126 offset:64
    s_waitcnt vmcnt(0)
    v_not_b32 v114, v114
    s_cmp_lg_u32 s57, 7
    s_cbranch_scc1 L_proj
    s_sub_u32 s72, s65, s62
    s_add_u32 s72, s72, 3
    v_add_u32 v104, s64, v118
    s_cmp_ge_i32 s68, s72
    s_cbranch_scc1 L_pd_25
L_pl_24:
    ds_read_b32 v96, v1 offset:0
    s_sub_u32 s63, s63, 1
    s_cbranch_scc1 L_end
    s_waitcnt lgkmcnt(0)
    v_readfirstlane_b32 s68, v96
    s_cmp_lt_i32 s68, s72
    s_cbranch_scc1 L_pl_24
L_pd_25:
    ds_read_b64_tr_b16 v[160:161], v104 offset:0
    ds_read_b64_tr_b16 v[162:163], v104 offset:512
    ds_read_b64_tr_b16 v[164:165], v104 offset:4096
    ds_read_b64_tr_b16 v[166:167], v104 offset:4608
    ds_read_b64_tr_b16 v[168:169], v104 offset:8192
    ds_read_b64_tr_b16 v[170:171], v104 offset:8704
    ds_read_b64_tr_b16 v[172:173], v104 offset:12288
    ds_read_b64_tr_b16 v[174:175], v104 offset:12800
    s_add_u32 s65, s65, 4
    s_addk_i32 s64, 0x4000
    s_cmp_eq_u32 s64, s74
    s_cselect_b32 s64, s75, s64
    v_add_u32 v94, 1, v94
    s_waitcnt lgkmcnt(0)
    ds_write_b32 v95, v94 offset:16
    s_sub_u32 s72, s65, s62
L_pad27:
    s_cbranch_execz L_pad28
    s_add_u32 s72, s72, 3
    v_add_u32 v104, s64, v118
    s_cmp_ge_i32 s68, s72
    s_cbranch_scc1 L_pd_27
L_pl_26:
    ds_read_b32 v96, v1 offset:0
    s_sub_u32 s63, s63, 1
    s_cbranch_scc1 L_end
    s_waitcnt lgkmcnt(0)
    v_readfirstlane_b32 s68, v96
    s_cmp_lt_i32 s68, s72
    s_cbranch_scc1 L_pl_26
L_pd_27:
    ds_read_b64_tr_b16 v[176:177], v104 offset:0
    ds_read_b64_tr_b16 v[178:179], v104 offset:512
    ds_read_b64_tr_b16 v[180:181], v104 offset:4096
    ds_read_b64_tr_b16 v[182:183], v104 offset:4608
    ds_read_b64_tr_b16 v[184:185], v104 offset:8192
    ds_read_b64_tr_b16 v[186:187], v104 offset:8704
    ds_read_b64_tr_b16 v[188:189], v104 offset:12288
    ds_read_b64_tr_b16 v[190:191], v104 offset:12800
    s_add_u32 s65, s65, 4
    s_addk_i32 s64, 0x4000
    s_cmp_eq_u32 s64, s74
    s_cselect_b32 s64, s75, s64
    v_add_u32 v94, 1, v94
    s_waitcnt lgkmcnt(0)
    ds_write_b32 v95, v94 offset:16
    s_branch L_proj
L_projA_done:
    ds_write_b32 v95, v94 offset:16
    v_mov_b32 v160, v176
    v_mov_b32 v161, v177
    v_mov_b32 v162, v178
    v_mov_b32 v163, v179
    v_mov_b32 v164, v180
    v_mov_b32 v165, v181
    v_mov_b32 v166, v182
    v_mov_b32 v167, v183
    v_mov_b32 v168, v184
    v_mov_b32 v169, v185
    v_mov_b32 v170, v186
    v_mov_b32 v171, v187
    v_mov_b32 v172, v188
    v_mov_b32 v173, v189
    v_mov_b32 v174, v190
    v_mov_b32 v175, v191
    v_mov_b32 v126, v127
    s_add_u32 s76, s76, 163840
    s_add_u32 s77, s77, 163840
    s_branch L_vpass
L_b0:
    s_mov_b32 m0, s65
    s_waitcnt vmcnt(18)
L_pad28:
    s_cbranch_execz L_pad29
    buffer_load_dwordx4 v30, s[8:11], s64 offen nt lds
    s_addk_i32 m0, 0x400
    s_waitcnt vmcnt(18)
    buffer_load_dwordx4 v31, s[8:11], s64 offen nt lds
    s_addk_i32 m0, 0x400
    s_add_i32 s70, s67, -4
    s_max_i32 s73, s73, s70
    v_mov_b32 v19, s73
    s_waitcnt vmcnt(18)
    ds_write_b32 v1, v19 offset:0
    buffer_load_dwordx4 v32, s[8:11], s64 offen nt lds
    s_addk_i32 m0, 0x400
    s_waitcnt vmcnt(18)
    buffer_load_dwordx4 v33, s[8:11], s64 offen nt lds
    s_addk_i32 m0, 0x400
    s_add_u32 s68, s64, s12
    s_waitcnt vmcnt(18)
    buffer_load_dwordx4 v30, s[8:11], s68 offen nt lds
    s_addk_i32 m0, 0x400
    s_waitcnt vmcnt(18)
    buffer_load_dwordx4 v31, s[8:11], s68 offen nt lds
    s_addk_i32 m0, 0x400
    s_add_i32 s70, s67, -3
    s_max_i32 s73, s73, s70
    v_mov_b32 v19, s73
    s_waitcnt vmcnt(18)
    ds_write_b32 v1, v19 offset:0
    buffer_load_dwordx4 v32, s[8:11], s68 offen nt lds
    s_addk_i32 m0, 0x400
    s_waitcnt vmcnt(18)
    buffer_load_dwordx4 v33, s[8:11], s68 offen nt lds
    s_addk_i32 m0, 0x400
    s_add_u32 s68, s64, s13
    s_waitcnt vmcnt(18)
    buffer_load_dwordx4 v30, s[8:11], s68 offen nt lds
    s_addk_i32 m0, 0x400
    s_waitcnt vmcnt(18)
    buffer_load_dwordx4 v31, s[8:11], s68 offen nt lds
    s_addk_i32 m0, 0x400
    s_add_i32 s70, s67, -2
    s_max_i32 s73, s73, s70
    v_mov_b32 v19, s73
    s_waitcnt vmcnt(18)
    ds_write_b32 v1, v19 offset:0
    buffer_load_dwordx4 v32, s[8:11], s68 offen nt lds
    ds_read_b128 v[20:23], v1 offset:16
    ds_read_b32 v34, v1 offset:52
L_pad29:
    s_cbranch_execz L_pad30
    s_addk_i32 m0, 0x400
    s_waitcnt vmcnt(18)
    buffer_load_dwordx4 v33, s[8:11], s68 offen nt lds
    s_addk_i32 m0, 0x400
    s_add_u32 s68, s64, s14
    s_waitcnt vmcnt(18)
    buffer_load_dwordx4 v30, s[8:11], s68 offen nt lds
    s_addk_i32 m0, 0x400
    s_waitcnt vmcnt(18)
    buffer_load_dwordx4 v31, s[8:11], s68 offen nt lds
    s_addk_i32 m0, 0x400
    s_add_i32 s70, s67, -1
    s_max_i32 s73, s73, s70
    v_mov_b32 v19, s73
    s_waitcnt vmcnt(18)
    ds_write_b32 v1, v19 offset:0
    buffer_load_dwordx4 v32, s[8:11], s68 offen nt lds
    s_addk_i32 m0, 0x400
    s_waitcnt vmcnt(18)
    buffer_load_dwordx4 v33, s[8:11], s68 offen nt lds
    s_branch L_ld_next
L_b1:
    s_mov_b32 m0, s65
    s_add_i32 s70, s67, -5
    s_max_i32 s73, s73, s70
    v_mov_b32 v19, s73
    s_waitcnt vmcnt(20)
    ds_write_b32 v1, v19 offset:0
    buffer_load_dwordx4 v30, s[8:11], s64 offen nt lds
    s_addk_i32 m0, 0x400
    s_waitcnt vmcnt(20)
    buffer_load_dwordx4 v31, s[8:11], s64 offen nt lds
    s_addk_i32 m0, 0x400
    s_waitcnt vmcnt(20)
    buffer_load_dwordx4 v32, s[8:11], s64 offen nt lds
    s_addk_i32 m0, 0x400
    s_waitcnt vmcnt(20)
    buffer_load_dwordx4 v33, s[8:11], s64 offen nt lds
    s_addk_i32 m0, 0x400
    s_add_u32 s68, s64, s12
    s_add_i32 s70, s67, -4
    s_max_i32 s73, s73, s70
    v_mov_b32 v19, s73
    s_waitcnt vmcnt(20)
    ds_write_b32 v1, v19 offset:0
    buffer_load_dwordx4 v30, s[8:11], s68 offen nt lds
    s_addk_i32 m0, 0x400
    s_waitcnt vmcnt(20)
    buffer_load_dwordx4 v31, s[8:11], s68 offen nt lds
    s_addk_i32 m0, 0x400
L_pad30:
    s_cbranch_execz L_pad31
    s_waitcnt vmcnt(20)
    buffer_load_dwordx4 v32, s[8:11], s68 offen nt lds
    s_addk_i32 m0, 0x400
    s_waitcnt vmcnt(20)
    buffer_load_dwordx4 v33, s[8:11], s68 offen nt lds
    s_addk_i32 m0, 0x400
    s_add_u32 s68, s64, s13
    s_add_i32 s70, s67, -3
    s_max_i32 s73, s73, s70
    v_mov_b32 v19, s73
    s_waitcnt vmcnt(20)
    ds_write_b32 v1, v19 offset:0
    buffer_load_dwordx4 v30, s[8:11], s68 offen nt lds
    s_addk_i32 m0, 0x400
    s_waitcnt vmcnt(20)
    buffer_load_dwordx4 v31, s[8:11], s68 offen nt lds
    s_addk_i32 m0, 0x400
    s_waitcnt vmcnt(20)
    buffer_load_dwordx4 v32, s[8:11], s68 offen nt lds
    ds_read_b128 v[20:23], v1 offset:16
    ds_read_b32 v34, v1 offset:52
    s_addk_i32 m0, 0x400
    s_waitcnt vmcnt(20)
    buffer_load_dwordx4 v33, s[8:11], s68 offen nt lds
    s_addk_i32 m0, 0x400
    s_add_u32 s68, s64, s14
    s_add_i32 s70, s67, -2
    s_max_i32 s73, s73, s70
    v_mov_b32 v19, s73
    s_waitcnt vmcnt(20)
    ds_write_b32 v1, v19 offset:0
    buffer_load_dwordx4 v30, s[8:11], s68 offen nt lds
    s_addk_i32 m0, 0x400
    s_waitcnt vmcnt(20)
    buffer_load_dwordx4 v31, s[8:11], s68 offen nt lds
    s_addk_i32 m0, 0x400
    s_waitcnt vmcnt(20)
    buffer_load_dwordx4 v32, s[8:11], s68 offen nt lds
    s_addk_i32 m0, 0x400
    s_waitcnt vmcnt(20)
    buffer_load_dwordx4 v33, s[8:11], s68 offen nt lds
    s_branch L_ld_next
L_b3:
    s_mov_b32 m0, s65
    s_waitcnt vmcnt(22)
    buffer_load_dwordx4 v30, s[8:11], s64 offen nt lds
    s_addk_i32 m0, 0x400
    s_waitcnt vmcnt(22)
    buffer_load_dwordx4 v31, s[8:11], s64 offen nt lds
L_pad31:
    s_cbranch_execz L_pad32
    s_addk_i32 m0, 0x400
    s_add_i32 s70, s67, -5
    s_max_i32 s73, s73, s70
    v_mov_b32 v19, s73
    s_waitcnt vmcnt(22)
    ds_write_b32 v1, v19 offset:0
    buffer_load_dwordx4 v32, s[8:11], s64 offen nt lds
    s_addk_i32 m0, 0x400
    s_waitcnt vmcnt(22)
    buffer_load_dwordx4 v33, s[8:11], s64 offen nt lds
    s_addk_i32 m0, 0x400
    s_add_u32 s68, s64, s12
    s_waitcnt vmcnt(22)
    buffer_load_dwordx4 v30, s[8:11], s68 offen nt lds
    s_addk_i32 m0, 0x400
    s_waitcnt vmcnt(22)
    buffer_load_dwordx4 v31, s[8:11], s68 offen nt lds
    s_addk_i32 m0, 0x400
    s_add_i32 s70, s67, -4
    s_max_i32 s73, s73, s70
    v_mov_b32 v19, s73
    s_waitcnt vmcnt(22)
    ds_write_b32 v1, v19 offset:0
    buffer_load_dwordx4 v32, s[8:11], s68 offen nt lds
    s_addk_i32 m0, 0x400
    s_waitcnt vmcnt(22)
    buffer_load_dwordx4 v33, s[8:11], s68 offen nt lds
    s_addk_i32 m0, 0x400
    s_add_u32 s68, s64, s13
    s_waitcnt vmcnt(22)
    buffer_load_dwordx4 v30, s[8:11], s68 offen nt lds
    s_addk_i32 m0, 0x400
    s_waitcnt vmcnt(22)
    buffer_load_dwordx4 v31, s[8:11], s68 offen nt lds
    s_addk_i32 m0, 0x400
    s_add_i32 s70, s67, -3
    s_max_i32 s73, s73, s70
    v_mov_b32 v19, s73
    s_waitcnt vmcnt(22)
    ds_write_b32 v1, v19 offset:0
    buffer_load_dwordx4 v32, s[8:11], s68 offen nt lds
    ds_read_b128 v[20:23], v1 offset:16
    ds_read_b32 v34, v1 offset:52
    s_addk_i32 m0, 0x400
    s_waitcnt vmcnt(22)
    buffer_load_dwordx4 v33, s[8:11], s68 offen nt lds
    s_addk_i32 m0, 0x400
L_pad32:
    s_cbranch_execz L_pad33
    s_add_u32 s68, s64, s14
    s_waitcnt vmcnt(22)
    buffer_load_dwordx4 v30, s[8:11], s68 offen nt lds
    s_addk_i32 m0, 0x400
    s_waitcnt vmcnt(22)
    buffer_load_dwordx4 v31, s[8:11], s68 offen nt lds
    s_addk_i32 m0, 0x400
    s_add_i32 s70, s67, -2
    s_max_i32 s73, s73, s70
    v_mov_b32 v19, s73
    s_waitcnt vmcnt(22)
    ds_write_b32 v1, v19 offset:0
    buffer_load_dwordx4 v32, s[8:11], s68 offen nt lds
    s_addk_i32 m0, 0x400
    s_waitcnt vmcnt(22)
    buffer_load_dwordx4 v33, s[8:11], s68 offen nt lds
    s_branch L_ld_next
L_b4:
    s_mov_b32 m0, s65
    s_waitcnt vmcnt(23)
    buffer_load_dwordx4 v30, s[8:11], s64 offen nt lds
    s_addk_i32 m0, 0x400
    s_waitcnt vmcnt(23)
    buffer_load_dwordx4 v31, s[8:11], s64 offen nt lds
    s_addk_i32 m0, 0x400
    s_waitcnt vmcnt(23)
    buffer_load_dwordx4 v32, s[8:11], s64 offen nt lds
    s_addk_i32 m0, 0x400
    s_add_i32 s70, s67, -5
    s_max_i32 s73, s73, s70
    v_mov_b32 v19, s73
    s_waitcnt vmcnt(23)
    ds_write_b32 v1, v19 offset:0
    buffer_load_dwordx4 v33, s[8:11], s64 offen nt lds
    s_addk_i32 m0, 0x400
    s_add_u32 s68, s64, s12
    s_waitcnt vmcnt(23)
    buffer_load_dwordx4 v30, s[8:11], s68 offen nt lds
    s_addk_i32 m0, 0x400
    s_waitcnt vmcnt(23)
    buffer_load_dwordx4 v31, s[8:11], s68 offen nt lds
    s_addk_i32 m0, 0x400
    s_waitcnt vmcnt(23)
    buffer_load_dwordx4 v32, s[8:11], s68 offen nt lds
    s_addk_i32 m0, 0x400
    s_add_i32 s70, s67, -4
    s_max_i32 s73, s73, s70
    v_mov_b32 v19, s73
    s_waitcnt vmcnt(23)
    ds_write_b32 v1, v19 offset:0
L_pad33:
    s_cbranch_execz L_pad34
    buffer_load_dwordx4 v33, s[8:11], s68 offen nt lds
    s_addk_i32 m0, 0x400
    s_add_u32 s68, s64, s13
    s_waitcnt vmcnt(23)
    buffer_load_dwordx4 v30, s[8:11], s68 offen nt lds
    s_addk_i32 m0, 0x400
    s_waitcnt vmcnt(23)
    buffer_load_dwordx4 v31, s[8:11], s68 offen nt lds
    s_addk_i32 m0, 0x400
    s_waitcnt vmcnt(23)
    buffer_load_dwordx4 v32, s[8:11], s68 offen nt lds
    ds_read_b128 v[20:23], v1 offset:16
    ds_read_b32 v34, v1 offset:52
    s_addk_i32 m0, 0x400
    s_add_i32 s70, s67, -3
    s_max_i32 s73, s73, s70
    v_mov_b32 v19, s73
    s_waitcnt vmcnt(23)
    ds_write_b32 v1, v19 offset:0
    buffer_load_dwordx4 v33, s[8:11], s68 offen nt lds
    s_addk_i32 m0, 0x400
    s_add_u32 s68, s64, s14
    s_waitcnt vmcnt(23)
    buffer_load_dwordx4 v30, s[8:11], s68 offen nt lds
    s_addk_i32 m0, 0x400
    s_waitcnt vmcnt(23)
    buffer_load_dwordx4 v31, s[8:11], s68 offen nt lds
    s_addk_i32 m0, 0x400
    s_waitcnt vmcnt(23)
    buffer_load_dwordx4 v32, s[8:11], s68 offen nt lds
    s_addk_i32 m0, 0x400
    s_add_i32 s70, s67, -2
    s_max_i32 s73, s73, s70
    v_mov_b32 v19, s73
    s_waitcnt vmcnt(23)
    ds_write_b32 v1, v19 offset:0
    buffer_load_dwordx4 v33, s[8:11], s68 offen nt lds
    s_branch L_ld_next
L_b5:
    s_mov_b32 m0, s65
    s_add_i32 s70, s67, -6
    s_max_i32 s73, s73, s70
    v_mov_b32 v19, s73
    s_waitcnt vmcnt(24)
    ds_write_b32 v1, v19 offset:0
    buffer_load_dwordx4 v30, s[8:11], s64 offen nt lds
    s_addk_i32 m0, 0x400
    s_waitcnt vmcnt(24)
    buffer_load_dwordx4 v31, s[8:11], s64 offen nt lds
L_pad34:
    s_cbranch_execz L_pad35
    s_addk_i32 m0, 0x400
    s_waitcnt vmcnt(24)
    buffer_load_dwordx4 v32, s[8:11], s64 offen nt lds
    s_addk_i32 m0, 0x400
    s_waitcnt vmcnt(24)
    buffer_load_dwordx4 v33, s[8:11], s64 offen nt lds
    s_addk_i32 m0, 0x400
    s_add_u32 s68, s64, s12
    s_add_i32 s70, s67, -5
    s_max_i32 s73, s73, s70
    v_mov_b32 v19, s73
    s_waitcnt vmcnt(24)
    ds_write_b32 v1, v19 offset:0
    buffer_load_dwordx4 v30, s[8:11], s68 offen nt lds
    s_addk_i32 m0, 0x400
    s_waitcnt vmcnt(24)
    buffer_load_dwordx4 v31, s[8:11], s68 offen nt lds
    s_addk_i32 m0, 0x400
    s_waitcnt vmcnt(24)
    buffer_load_dwordx4 v32, s[8:11], s68 offen nt lds
    s_addk_i32 m0, 0x400
    s_waitcnt vmcnt(24)
    buffer_load_dwordx4 v33, s[8:11], s68 offen nt lds
    s_addk_i32 m0, 0x400
    s_add_u32 s68, s64, s13
    s_add_i32 s70, s67, -4
    s_max_i32 s73, s73, s70
    v_mov_b32 v19, s73
    s_waitcnt vmcnt(24)
    ds_write_b32 v1, v19 offset:0
    buffer_load_dwordx4 v30, s[8:11], s68 offen nt lds
    s_addk_i32 m0, 0x400
    s_waitcnt vmcnt(24)
    buffer_load_dwordx4 v31, s[8:11], s68 offen nt lds
    s_addk_i32 m0, 0x400
    s_waitcnt vmcnt(24)
    buffer_load_dwordx4 v32, s[8:11], s68 offen nt lds
    ds_read_b128 v[20:23], v1 offset:16
    ds_read_b32 v34, v1 offset:52
    s_addk_i32 m0, 0x400
    s_waitcnt vmcnt(24)
    buffer_load_dwordx4 v33, s[8:11], s68 offen nt lds
    s_addk_i32 m0, 0x400
    s_add_u32 s68, s64, s14
    s_add_i32 s70, s67, -3
    s_max_i32 s73, s73, s70
    v_mov_b32 v19, s73
    s_waitcnt vmcnt(24)
L_pad35:
    s_cbranch_execz L_pad36
    ds_write_b32 v1, v19 offset:0
    buffer_load_dwordx4 v30, s[8:11], s68 offen nt lds
    s_addk_i32 m0, 0x400
    s_waitcnt vmcnt(24)
    buffer_load_dwordx4 v31, s[8:11], s68 offen nt lds
    s_addk_i32 m0, 0x400
    s_waitcnt vmcnt(24)
    buffer_load_dwordx4 v32, s[8:11], s68 offen nt lds
    s_addk_i32 m0, 0x400
    s_waitcnt vmcnt(24)
    buffer_load_dwordx4 v33, s[8:11], s68 offen nt lds
    s_branch L_ld_next
L_b6:
    s_mov_b32 m0, s65
    s_waitcnt vmcnt(26)
    buffer_load_dwordx4 v30, s[8:11], s64 offen nt lds
    s_addk_i32 m0, 0x400
    s_waitcnt vmcnt(26)
    buffer_load_dwordx4 v31, s[8:11], s64 offen nt lds
    s_addk_i32 m0, 0x400
    s_add_i32 s70, s67, -6
    s_max_i32 s73, s73, s70
    v_mov_b32 v19, s73
    s_waitcnt vmcnt(26)
    ds_write_b32 v1, v19 offset:0
    buffer_load_dwordx4 v32, s[8:11], s64 offen nt lds
    s_addk_i32 m0, 0x400
    s_waitcnt vmcnt(26)
    buffer_load_dwordx4 v33, s[8:11], s64 offen nt lds
    s_addk_i32 m0, 0x400
    s_add_u32 s68, s64, s12
    s_waitcnt vmcnt(26)
    buffer_load_dwordx4 v30, s[8:11], s68 offen nt lds
    s_addk_i32 m0, 0x400
    s_waitcnt vmcnt(26)
    buffer_load_dwordx4 v31, s[8:11], s68 offen nt lds
    s_addk_i32 m0, 0x400
    s_add_i32 s70, s67, -5
    s_max_i32 s73, s73, s70
    v_mov_b32 v19, s73
    s_waitcnt vmcnt(26)
    ds_write_b32 v1, v19 offset:0
    buffer_load_dwordx4 v32, s[8:11], s68 offen nt lds
    s_addk_i32 m0, 0x400
    s_waitcnt vmcnt(26)
    buffer_load_dwordx4 v33, s[8:11], s68 offen nt lds
    s_addk_i32 m0, 0x400
    s_add_u32 s68, s64, s13
    s_waitcnt vmcnt(26)
L_pad36:
    s_cbranch_execz L_pad37
    buffer_load_dwordx4 v30, s[8:11], s68 offen nt lds
    s_addk_i32 m0, 0x400
    s_waitcnt vmcnt(26)
    buffer_load_dwordx4 v31, s[8:11], s68 offen nt lds
    s_addk_i32 m0, 0x400
    s_add_i32 s70, s67, -4
    s_max_i32 s73, s73, s70
    v_mov_b32 v19, s73
    s_waitcnt vmcnt(26)
    ds_write_b32 v1, v19 offset:0
    buffer_load_dwordx4 v32, s[8:11], s68 offen nt lds
    ds_read_b128 v[20:23], v1 offset:16
    ds_read_b32 v34, v1 offset:52
    s_addk_i32 m0, 0x400
    s_waitcnt vmcnt(26)
    buffer_load_dwordx4 v33, s[8:11], s68 offen nt lds
    s_addk_i32 m0, 0x400
    s_add_u32 s68, s64, s14
    s_waitcnt vmcnt(26)
    buffer_load_dwordx4 v30, s[8:11], s68 offen nt lds
    s_addk_i32 m0, 0x400
    s_waitcnt vmcnt(26)
    buffer_load_dwordx4 v31, s[8:11], s68 offen nt lds
    s_addk_i32 m0, 0x400
    s_add_i32 s70, s67, -3
    s_max_i32 s73, s73, s70
    v_mov_b32 v19, s73
    s_waitcnt vmcnt(26)
    ds_write_b32 v1, v19 offset:0
    buffer_load_dwordx4 v32, s[8:11], s68 offen nt lds
    s_addk_i32 m0, 0x400
    s_waitcnt vmcnt(26)
    buffer_load_dwordx4 v33, s[8:11], s68 offen nt lds
    s_branch L_ld_next
L_b7:
    s_mov_b32 m0, s65
    s_waitcnt vmcnt(30)
    buffer_load_dwordx4 v30, s[8:11], s64 offen nt lds
    s_addk_i32 m0, 0x400
    s_waitcnt vmcnt(30)
    buffer_load_dwordx4 v31, s[8:11], s64 offen nt lds
    s_addk_i32 m0, 0x400
    s_add_i32 s70, s67, -7
    s_max_i32 s73, s73, s70
    v_mov_b32 v19, s73
    s_waitcnt vmcnt(30)
    ds_write_b32 v1, v19 offset:0
    buffer_load_dwordx4 v32, s[8:11], s64 offen nt lds
L_pad37:
    s_cbranch_execz L_pad38
    s_addk_i32 m0, 0x400
    s_waitcnt vmcnt(30)
    buffer_load_dwordx4 v33, s[8:11], s64 offen nt lds
    s_addk_i32 m0, 0x400
    s_add_u32 s68, s64, s12
    s_waitcnt vmcnt(30)
    buffer_load_dwordx4 v30, s[8:11], s68 offen nt lds
    s_addk_i32 m0, 0x400
    s_waitcnt vmcnt(30)
    buffer_load_dwordx4 v31, s[8:11], s68 offen nt lds
    s_addk_i32 m0, 0x400
    s_add_i32 s70, s67, -6
    s_max_i32 s73, s73, s70
    v_mov_b32 v19, s73
    s_waitcnt vmcnt(30)
    ds_write_b32 v1, v19 offset:0
    buffer_load_dwordx4 v32, s[8:11], s68 offen nt lds
    s_addk_i32 m0, 0x400
    s_waitcnt vmcnt(30)
    buffer_load_dwordx4 v33, s[8:11], s68 offen nt lds
    s_addk_i32 m0, 0x400
    s_add_u32 s68, s64, s13
    s_waitcnt vmcnt(30)
    buffer_load_dwordx4 v30, s[8:11], s68 offen nt lds
    s_addk_i32 m0, 0x400
    s_waitcnt vmcnt(30)
    buffer_load_dwordx4 v31, s[8:11], s68 offen nt lds
    s_addk_i32 m0, 0x400
    s_add_i32 s70, s67, -5
    s_max_i32 s73, s73, s70
    v_mov_b32 v19, s73
    s_waitcnt vmcnt(30)
    ds_write_b32 v1, v19 offset:0
    buffer_load_dwordx4 v32, s[8:11], s68 offen nt lds
    ds_read_b128 v[20:23], v1 offset:16
    ds_read_b32 v34, v1 offset:52
    s_addk_i32 m0, 0x400
    s_waitcnt vmcnt(30)
    buffer_load_dwordx4 v33, s[8:11], s68 offen nt lds
    s_addk_i32 m0, 0x400
    s_add_u32 s68, s64, s14
    s_waitcnt vmcnt(30)
    buffer_load_dwordx4 v30, s[8:11], s68 offen nt lds
    s_addk_i32 m0, 0x400
    s_waitcnt vmcnt(30)
    buffer_load_dwordx4 v31, s[8:11], s68 offen nt lds
    s_addk_i32 m0, 0x400
    s_add_i32 s70, s67, -4
L_pad38:
    s_cbranch_execz L_pad39
    s_max_i32 s73, s73, s70
    v_mov_b32 v19, s73
    s_waitcnt vmcnt(30)
    ds_write_b32 v1, v19 offset:0
    buffer_load_dwordx4 v32, s[8:11], s68 offen nt lds
    s_addk_i32 m0, 0x400
    s_waitcnt vmcnt(30)
    buffer_load_dwordx4 v33, s[8:11], s68 offen nt lds
    s_branch L_ld_next
L_ld_phase:
    s_add_u32 s75, s75, 1
    s_cmp_eq_u32 s75, 8
    s_cbranch_scc1 L_ld_drain
    s_bitcmp1_b32 0x46, s75
    s_cbranch_scc1 L_ld_kv
    s_cmp_eq_u32 s57, 7
    s_cselect_b32 s3, 3, 5
    s_max_u32 s75, s75, s3
    s_bitcmp1_b32 0x90, s75
    s_cselect_b64 s[8:9], s[46:47], s[44:45]
    s_mov_b32 s10, 4718592
    s_lshl_b32 s64, s60, 1
    s_add_u32 s64, s64, s58
    s_mul_i32 s64, s64, 147456
    s_lshl_b32 s3, s57, 7
    s_cmp_lt_u32 s75, 5
    s_cselect_b32 s3, 1024, s3
    s_add_u32 s64, s64, s3
    s_mov_b32 s12, 36864
    s_mov_b32 s13, 73728
    s_mov_b32 s14, 110592
    s_add_u32 s69, s67, 4
    v_lshrrev_b32 v24, 3, v0
    v_mul_u32_u24 v24, 1152, v24
    v_and_b32 v25, 1, v2
    v_lshlrev_b32 v25, 1, v25
    v_and_b32 v30, 7, v0
    v_xor_b32 v25, v25, v30
    v_lshl_add_u32 v30, v25, 4, v24
    v_xor_b32 v24, 64, v30
    v_add_u32 v31, 9216, v24
    v_add_u32 v32, 18432, v30
    v_add_u32 v33, 27648, v24
    s_branch L_ld_go
L_ld_kv:
    s_add_u32 s69, s67, 128
    s_mov_b64 s[8:9], s[42:43]
    s_mov_b64 s[42:43], s[36:37]
L_pad39:
    s_cbranch_execz L_pad40
    s_mov_b64 s[36:37], s[38:39]
    s_cmp_eq_u32 s75, 2
    s_cbranch_scc1 L_ld_tok
    s_brev_b32 s10, 16
    s_mov_b32 s64, s72
    s_mov_b32 s77, 0
    s_mov_b32 s12, 256
    s_mov_b32 s13, 4096
    s_mov_b32 s14, 4352
    v_add_u32 v30, 0, v17
    v_add_u32 v31, 16384, v17
    v_add_u32 v32, 2097152, v17
    v_add_u32 v33, 2113536, v17
    s_branch L_ld_go
L_ld_tok:
    v_xor_b32 v24, v2, v3
    v_lshlrev_b32 v24, 4, v24
    v_and_b32 v30, 1, v2
    v_lshl_add_u32 v24, v30, 11, v24
    v_lshrrev_b32 v30, 1, v2
    v_lshl_add_u32 v30, v30, 13, v24
    v_xor_b32 v31, 16448, v30
    v_xor_b32 v32, 2097280, v30
    v_xor_b32 v33, 2113728, v30
    s_branch L_ld_go
L_ld_drain:
    s_add_i32 s70, s67, -7
    s_max_i32 s73, s73, s70
    v_mov_b32 v19, s73
    s_waitcnt vmcnt(28)
    ds_write_b32 v1, v19 offset:0
    s_add_i32 s70, s67, -6
    s_max_i32 s73, s73, s70
    v_mov_b32 v19, s73
    s_waitcnt vmcnt(24)
    ds_write_b32 v1, v19 offset:0
    s_add_i32 s70, s67, -5
    s_max_i32 s73, s73, s70
    v_mov_b32 v19, s73
    s_waitcnt vmcnt(20)
    ds_write_b32 v1, v19 offset:0
    s_add_i32 s70, s67, -4
    s_max_i32 s73, s73, s70
    v_mov_b32 v19, s73
    s_waitcnt vmcnt(16)
    ds_write_b32 v1, v19 offset:0
    s_add_i32 s70, s67, -3
    s_max_i32 s73, s73, s70
    v_mov_b32 v19, s73
    s_waitcnt vmcnt(12)
L_pad40:
    s_cbranch_execz L_pad41
    ds_write_b32 v1, v19 offset:0
    s_add_i32 s70, s67, -2
    s_max_i32 s73, s73, s70
    v_mov_b32 v19, s73
    s_waitcnt vmcnt(8)
    ds_write_b32 v1, v19 offset:0
    s_add_i32 s70, s67, -1
    s_max_i32 s73, s73, s70
    v_mov_b32 v19, s73
    s_waitcnt vmcnt(4)
    ds_write_b32 v1, v19 offset:0
    s_add_i32 s70, s67, 0
    s_max_i32 s73, s73, s70
    v_mov_b32 v19, s73
    s_waitcnt vmcnt(0)
    ds_write_b32 v1, v19 offset:0
    s_branch L_end
L_ctl_done:
    s_cmp_lg_u32 s46, 0x80
    s_cbranch_scc1 L_nocfin
    v_mov_b32 v97, 540
    s_mov_b64 exec, 1
    buffer_store_dword v97, off, s[4:7], s45
    s_mov_b64 exec, -1
L_nocfin:
    s_cmp_ge_u32 s68, 72
    s_cbranch_scc1 L_end
    s_mov_b64 s[32:33], s[50:51]
    s_movk_i32 s34, 2304
    s_mov_b32 s35, 0x20000
    s_lshl_b32 s73, s68, 5
    v_and_b32 v102, 3, v0
    v_lshl_add_u32 v102, v102, 2, v2
    v_lshlrev_b32 v102, 1, v102
    v_lshlrev_b32 v98, 2, v3
    s_mov_b64 s[8:9], -1
    s_mov_b64 s[10:11], -1
    s_mov_b32 s72, 0
    s_barrier
L_hop2:
    s_mov_b64 exec, s[8:9]
    s_cbranch_execz L_sk_5
    buffer_load_dwordx4 v[36:39], v16, s[4:7], s16 offen sc1
L_sk_5:
    s_mov_b64 exec, s[10:11]
    s_cbranch_execz L_sk_6
    buffer_load_dwordx4 v[40:43], v16, s[4:7], s62 offen sc1
L_sk_6:
    s_mov_b64 exec, -1
    s_sub_u32 s63, s63, 1
    s_cbranch_scc1 L_end
    s_waitcnt vmcnt(0)
L_hop2_chk:
    v_bitop3_b32 v103, 1, v36, v68 bitop3:0x60
    v_bitop3_b32 v104, 1, v40, v72 bitop3:0x60
L_pad41:
    s_cbranch_execz L_exit
    v_bitop3_b32 v103, v103, v37, v69 bitop3:0x60
    v_bitop3_b32 v104, v104, v41, v73 bitop3:0x60
    v_bitop3_b32 v103, v103, v38, v70 bitop3:0x60
    v_bitop3_b32 v104, v104, v42, v74 bitop3:0x60
    v_bitop3_b32 v103, v103, v39, v71 bitop3:0x60
    v_bitop3_b32 v104, v104, v43, v75 bitop3:0x60
    v_cmp_eq_u32 s[8:9], 0, v103
    v_cmp_eq_u32 s[10:11], 0, v104
    s_or_b64 s[20:21], s[8:9], s[10:11]
    s_cbranch_scc1 L_hop2
    v_and_b32 v44, -2, v36
    v_and_b32 v48, -2, v40
    v_and_b32 v46, -2, v38
    v_and_b32 v50, -2, v42
    v_and_b32 v45, -2, v37
    v_and_b32 v49, -2, v41
    v_and_b32 v47, -2, v39
    v_and_b32 v51, -2, v43
    v_add_f32 v44, v44, v48
    v_add_f32 v46, v46, v50
    v_add_f32 v45, v45, v49
    v_add_f32 v47, v47, v51
    v_permlane32_swap_b32 v44, v46
    s_nop 0
    v_permlane32_swap_b32 v45, v47
    v_add_f32 v44, v44, v46
    v_add_f32 v45, v45, v47
    s_nop 1
    v_permlane16_swap_b32 v44, v45
    v_add_f32 v44, v44, v45
    s_nop 1
    v_add_f32_dpp v44, v44, v44 row_ror:4 row_mask:0xf bank_mask:0xf
    s_nop 1
    v_add_f32_dpp v44, v44, v44 row_ror:8 row_mask:0xf bank_mask:0xf
    s_mov_b32 exec_lo, 0x000f000f
    s_mov_b32 exec_hi, 0x000f000f
    v_cvt_pk_bf16_f32 v44, v44, v44
    buffer_store_short v44, v102, s[32:35], s73 offen
    s_cmp_lg_u32 s68, 0
    s_cbranch_scc1 L_end
    s_mov_b64 exec, 0xffff
    buffer_store_dword v1, v98, s[28:31], 0 offen offset:128
    s_branch L_end
L_end:
L_exit:
    s_endpgm
L_flush_slow:
    buffer_store_dwordx2 v[36:37], v12, s[4:7], s59 offen sc1
    v_add_f32 v102, v102, v103
    v_add_f32 v93, v104, v93
    v_add_f32 v93, v102, v93
    s_mov_b64 exec, 0x101
    v_min_u32 v93, -2, v93
    buffer_store_dwordx2 v[92:93], v119, s[4:7], s46 offen sc1
    s_mov_b64 exec, -1
    s_branch L_flush_done
.section .rodata,"a"
.p2align 6
.amdhsa_kernel gated_mix__gqa_block_cached__gqa_block_cached__decode_kernel
  .amdhsa_next_free_vgpr 192
  .amdhsa_next_free_sgpr 102
  .amdhsa_accum_offset 192
  .amdhsa_group_segment_fixed_size 0
  .amdhsa_kernarg_size 112
  .amdhsa_user_sgpr_count 2
  .amdhsa_user_sgpr_kernarg_segment_ptr 1
  .amdhsa_system_sgpr_workgroup_id_x 1
  .amdhsa_float_denorm_mode_32 3
.end_amdhsa_kernel
```
